```python
import torch

def _softmax(x, axis=-1):
    return torch.softmax(x, dim=axis)
def _gelu(x):
    return torch.nn.functional.gelu(x, approximate="tanh")
def _silu(x):
    return torch.nn.functional.silu(x)
def _sigmoid(x):
    return torch.sigmoid(x)
def _layernorm(x, axis=-1, eps=1e-5):
    m = x.mean(dim=axis, keepdim=True)
    v = x.var(dim=axis, keepdim=True, unbiased=False)
    return (x - m) / torch.sqrt(v + eps)
def _scatter_add(tgt, idx, src, axis=0):
    return tgt.clone().index_add_(axis, idx, src)
def _segment_sum(src, seg, n):
    out = torch.zeros((n,) + src.shape[1:], dtype=src.dtype)
    return out.index_add_(0, seg, src)
def _pad(x, pw):
    flat = tuple(v for pair in reversed(pw) for v in pair)
    return torch.nn.functional.pad(x, flat)

kernel_name = 'gather_scatter__mpnn_edge_mlp__graph'

def setup_inputs():

    _w = (lambda a: (lambda t: t.to(torch.bfloat16) if t.is_floating_point() else t)(torch.as_tensor(a)))
    N, deg, D, De = 10000, 16, 256, max(0, 1)
    E = N * deg
    return {
        "x": _w((lambda *s: torch.randn(*s, dtype=torch.bfloat16) * 0.05)(N, D)),
        "e_attr": _w((lambda *s: torch.randn(*s, dtype=torch.bfloat16) * 0.4)(E, De)),
        "src": _w((lambda lo, hi, *s: torch.randint(lo, hi, s))(0, N, E).to(torch.int64)),
        "dst": _w((lambda lo, hi, *s: torch.randint(lo, hi, s))(0, N, E).to(torch.int64)),
        "w_msg": _w((lambda *s: torch.randn(*s, dtype=torch.bfloat16) * 0.4)(2 * D + De, D)),
        "w_upd": _w((lambda *s: torch.randn(*s, dtype=torch.bfloat16) * 0.05)(2 * D, D)),
    }

def reference(x, e_attr, src, dst, w_msg, w_upd):
    N, D = x.shape
    m_in = torch.concatenate([x[src], x[dst], e_attr], axis=-1)
    msg = _silu(m_in @ w_msg)
    agg = _segment_sum(msg, dst, N)
    return _silu(torch.concatenate([x, agg], axis=-1) @ w_upd)
```

```asm
; @launch grid=(256,1,1) block=(1024,1,1) lds=157696
.amdgcn_target "amdgcn-amd-amdhsa--gfx950"
.text
    .globl gather_scatter__mpnn_edge_mlp__graph_kernel
    .p2align 8
    .type gather_scatter__mpnn_edge_mlp__graph_kernel,@function
gather_scatter__mpnn_edge_mlp__graph_kernel:
    s_cmp_ge_u32 s2, 256
    s_cbranch_scc1 L_end
    s_load_dwordx2 s[28:29], s[0:1], 0
    s_load_dwordx2 s[44:45], s[0:1], 32
    s_load_dwordx2 s[36:37], s[0:1], 24
    s_load_dwordx2 s[12:13], s[0:1], 16
    s_load_dwordx2 s[52:53], s[0:1], 8
    s_load_dwordx2 s[40:41], s[0:1], 40
    s_load_dwordx2 s[32:33], s[0:1], 64
    s_load_dwordx2 s[96:97], s[0:1], 56
    s_load_dwordx2 s[20:21], s[0:1], 48
    s_memrealtime s[100:101]
    v_lshrrev_b32 v2, 6, v0
    v_and_b32 v1, 63, v0
    s_mul_i32 s4, s2, 481
    v_readfirstlane_b32 s3, v2
    v_lshrrev_b32 v4, 5, v1
    v_and_b32 v6, 31, v1
    s_sub_u32 s4, s4, 30773
    s_add_u32 s5, s4, 481
    s_mul_i32 s4, s4, 43691
    s_mul_i32 s5, s5, 43691
    s_lshr_b32 s4, s4, 19
    s_lshr_b32 s5, s5, 19
    s_sub_u32 s5, s5, s4
    s_add_u32 s4, s4, 2304
    s_mul_i32 s50, s2, 36
    s_cmp_lt_u32 s2, 64
    s_cselect_b32 s4, s50, s4
    s_cselect_b32 s5, 36, s5
    s_lshl_b32 s50, s3, 1
    v_add_u32 v5, s50, v4
    v_lshlrev_b32 v2, 4, v0
    v_and_b32 v7, 15, v5
    v_xor_b32 v7, v7, v6
    v_lshlrev_b32 v7, 4, v7
    v_lshl_add_u32 v7, v4, 9, v7
    v_lshlrev_b32 v81, 2, v1
    v_mov_b32 v76, 0
    s_mov_b32 s30, 5120000
    s_mov_b32 s31, 0x20000
    s_mov_b32 s46, 262656
    s_mov_b32 s47, 0x20000
    s_mov_b32 s38, 640000
    s_mov_b32 s39, 0x20000
    s_mov_b32 s14, 640000
    s_mov_b32 s15, 0x20000
    s_mov_b32 s54, 320000
    s_mov_b32 s55, 0x20000
    s_mov_b32 s98, 256
    s_mov_b32 s99, 0x20000
    s_lshl_b32 s68, s3, 10
    s_lshl_b32 s51, s4, 9
    s_add_u32 s51, s51, s68
    s_add_u32 m0, s68, 133120
    s_cmp_ge_u32 s2, 64
    s_cbranch_scc1 F_nobl
    s_mul_i32 s49, s2, 10000
    s_mul_i32 s50, s2, 5000
    v_lshlrev_b32 v87, 3, v0
    s_cmp_ge_u32 s3, 10
    s_waitcnt lgkmcnt(0)
    s_cbranch_scc1 F_nel
    buffer_load_dwordx4 v[8:11], v2, s[36:39], s49 offen
    buffer_load_dwordx4 v[12:15], v2, s[12:15], s49 offen
    buffer_load_dwordx2 v[16:17], v87, s[52:55], s50 offen
    s_branch F_ne2
F_nel:
    s_sub_u32 s50, s3, 10
    s_cmp_ge_u32 s50, 2
    s_cbranch_scc1 F_ne2
    s_lshr_b32 s49, s2, 3
    s_lshl_b32 s49, s49, 13
    s_lshl_b32 s50, s50, 12
    s_add_u32 s49, s49, s50
    v_lshlrev_b32 v87, 6, v1
    buffer_load_dword v77, v87, s[44:47], s49 offen
F_ne2:
    v_lshlrev_b32 v87, 2, v0
    v_add_u32 v87, 131072, v87
    s_cmp_ge_u32 s3, 5
    s_cbranch_scc1 F_nbz
    ds_write_b32 v87, v76
F_nbz:
    s_waitcnt lgkmcnt(0)
    s_barrier
    s_add_u32 m0, s68, 133120
    s_cmp_ge_u32 s3, 4
    buffer_load_dwordx4 v7, s[28:31], s51 offen  lds
    s_cbranch_scc1 F_nox2b
    s_add_u32 m0, s68, 149504
    s_add_u32 s50, s51, 16384
    buffer_load_dwordx4 v7, s[28:31], s50 offen  lds
F_nox2b:
    s_branch F_nx
F_nobl:
    s_cmp_ge_u32 s3, 5
    s_waitcnt lgkmcnt(0)
    buffer_load_dwordx4 v7, s[28:31], s51 offen  lds
    s_cbranch_scc1 F_nox2
    s_add_u32 m0, s68, 149504
    s_add_u32 s50, s51, 16384
    buffer_load_dwordx4 v7, s[28:31], s50 offen  lds
    s_lshl_b32 s49, s2, 4
    s_add_u32 s49, s49, s3
    s_cmp_lg_u32 s49, 0xff0
    s_cbranch_scc1 F_nox2
    s_or_b32 s49, s100, 1
    v_mov_b32 v88, s49
    v_mov_b32 v89, s101
    s_mov_b64 exec, 1
    buffer_store_dwordx2 v[88:89], v76, s[96:99], 0 offen sc1
    s_mov_b64 exec, -1
F_nox2:
    s_sub_u32 s50, s3, 6
    s_cmp_ge_u32 s50, 2
    s_cbranch_scc1 F_ntc
    s_lshr_b32 s49, s2, 3
    s_lshl_b32 s49, s49, 13
    s_lshl_b32 s50, s50, 12
    s_add_u32 s49, s49, s50
    v_lshlrev_b32 v7, 6, v1
    buffer_load_dword v77, v7, s[44:47], s49 offen
F_ntc:
    s_mov_b32 s50, 262144
    buffer_load_dword v62, v81, s[44:47], s50 offen
    buffer_load_dword v63, v81, s[44:47], s50 offen offset:256
F_nx:
    v_and_b32 v87, 3, v5
    v_bfe_u32 v88, v5, 3, 1
    v_lshl_or_b32 v87, v88, 2, v87
    v_lshlrev_b32 v87, 1, v87
    v_xor_b32 v87, v87, v6
    v_lshlrev_b32 v87, 4, v87
    v_lshl_add_u32 v38, v4, 9, v87
    s_mov_b32 s42, 262144
    s_mov_b32 s43, 0x20000
    s_mov_b32 s34, 11534336
    s_mov_b32 s35, 0x20000
    s_sub_u32 s65, s100, 1500
    s_sub_u32 s48, s2, 64
    v_lshlrev_b32 v85, 3, v1
    v_lshrrev_b32 v3, 4, v1
    v_and_b32 v4, 15, v1
    v_xor_b32 v80, v4, v3
    v_lshlrev_b32 v80, 4, v80
    v_lshl_add_u32 v80, v4, 9, v80
    v_add_u32 v80, 133120, v80
    v_bfe_u32 v5, v1, 2, 2
    v_and_b32 v6, 3, v1
    v_lshl_add_u32 v36, v3, 3, v5
    v_lshlrev_b32 v36, 9, v36
    v_lshl_add_u32 v36, v6, 3, v36
    v_and_b32 v7, 1, v3
    v_lshl_or_b32 v87, v7, 2, v5
    v_xor_b32 v87, s3, v87
    v_lshl_add_u32 v36, v87, 5, v36
    v_add_u32 v83, 0x10000, v36
    v_add_u32 v91, 132352, v81
    ds_write2st64_b32 v91, v76, v76 offset0:0 offset1:1
    s_cmp_ge_u32 s48, 16
    s_cbranch_scc1 F_npd
    s_lshl_b32 s49, s48, 14
    s_add_u32 m0, s68, 65536
    s_add_u32 s49, s49, s68
    buffer_load_dwordx4 v38, s[40:43], s49 offen lds
F_npd:
    s_mov_b32 s74, 0xbfb8aa3b
    s_mov_b32 s75, 0xbfb8aa3b
    v_lshrrev_b32 v87, 1, v3
    s_lshl_b32 s77, s3, 1
    v_or_b32 v87, s77, v87
    v_xor_b32 v87, v87, v4
    v_lshlrev_b32 v87, 4, v87
    v_lshl_add_u32 v84, v4, 9, v87
    v_lshl_add_u32 v84, v7, 3, v84
    v_add_u32 v84, 0, v84
    v_lshrrev_b32 v78, 5, v0
    v_add_u32 v87, 32, v78
    v_cmp_gt_u32 vcc, s5, v87
    v_lshlrev_b32 v78, 4, v78
    v_xor_b32 v78, v78, v2
    v_add_u32 v78, 0, v78
    v_add_u32 v82, 0x4000, v2
    v_mov_b32 v87, 0x7ffffff0
    v_cndmask_b32 v82, v87, v82, vcc
    s_cmp_lt_u32 s2, 64
    s_cbranch_scc1 F_nd0
    s_add_u32 m0, s68, 0
    s_add_u32 s69, s68, 0
    buffer_load_dwordx4 v38, s[44:47], s69 offen lds
    s_add_u32 m0, s68, 16384
    s_add_u32 s69, s68, 16384
    buffer_load_dwordx4 v38, s[44:47], s69 offen lds
F_nd0:
    v_cmp_eq_u32 vcc, v5, v3
    v_and_b32 v89, 1, v1
    v_lshlrev_b32 v89, 4, v89
    v_mov_b32 v90, 0x3f80
    v_lshlrev_b32 v90, v89, v90
    v_cndmask_b32 v90, 0, v90, vcc
    v_xor_b32 v126, 2, v6
    v_lshlrev_b32 v126, 2, v126
    v_add_u32 v126, 99392, v126
    v_mov_b32 v89, 0x30000
    v_cndmask_b32 v126, v89, v126, vcc
    v_cmp_gt_u32 vcc, 2, v6
    v_mul_u32_u24 v34, 7, v5
    v_lshl_add_u32 v35, v6, 1, v34
    v_cndmask_b32 v32, 0, v90, vcc
    v_cndmask_b32_e64 v33, v90, 0, vcc
    v_cmp_eq_u32 vcc, 0, v6
    v_add_u32 v37, -1, v35
    v_mov_b32 v87, 64
    s_movk_i32 s76, 1040
    v_cndmask_b32 v37, v37, v87, vcc
    v_mul_u32_u24 v79, s76, v4
    v_lshl_add_u32 v79, v3, 4, v79
    s_lshl_b32 s76, s3, 6
    v_add_u32 v79, s76, v79
    s_mov_b64 s[8:9], s[32:33]
    s_mov_b32 s10, 5120000
    s_mov_b32 s11, 0x20000
    s_mov_b32 s16, s32
    s_or_b32 s17, s33, 0x40000
    s_mov_b32 s18, 5120000
    s_mov_b32 s19, 0x800000
    s_mov_b32 s72, 1.0
    s_mov_b32 s73, 1.0
    s_mov_b32 s79, 0x7b800000
    s_mov_b32 s26, 0
    s_cmp_lt_u32 s2, 64
    s_cbranch_scc1 F_bin
    s_barrier
    s_add_u32 m0, s68, 32768
    s_add_u32 s69, s68, 32768
    buffer_load_dwordx4 v38, s[44:47], s69 offen lds
    s_add_u32 m0, s68, 49152
    s_add_u32 s69, s68, 49152
    buffer_load_dwordx4 v38, s[44:47], s69 offen lds
    s_branch F_nbr
F_bin:
    s_movk_i32 s57, 625
    v_cmp_gt_u32 s[58:59], s57, v0
    s_mov_b32 s56, 418559
    s_mov_b32 s62, 233017
    v_mov_b32 v45, 109381888
    s_mov_b32 s60, 131072
    s_mov_b32 s61, 65536
    v_lshrrev_b32 v42, 3, v0
    v_and_b32 v43, 7, v0
    v_lshlrev_b32 v43, 4, v43
    v_lshl_add_u32 v41, v42, 14, v43
    v_and_b32 v40, 7, v42
    v_lshlrev_b32 v40, 4, v40
    v_xor_b32 v40, v40, v43
    v_lshl_add_u32 v40, v42, 8, v40
    v_add_u32 v40, s61, v40
    v_lshl_add_u32 v42, v42, 2, s60
    v_and_b32 v43, 48, v43
    v_cmp_eq_u32 s[22:23], 0, v43
    v_mov_b32 v43, 0x7f000000
    v_mov_b32 v44, 132096
    s_lshl_b32 s24, s2, 8
    s_add_u32 s24, s24, 7340032
    s_add_u32 s25, s24, 2097152
    s_cmp_lt_u32 s3, 4
    s_waitcnt vmcnt(2)
    s_cbranch_scc1 F_be
    s_waitcnt vmcnt(1)
F_be:
    buffer_load_dwordx2 v[92:93], v76, s[96:99], 0 offen sc1
    s_mov_b32 s50, 262144
    buffer_load_dword v62, v81, s[44:47], s50 offen
    buffer_load_dword v63, v81, s[44:47], s50 offen offset:256
    v_mov_b32 v90, 1
    s_movk_i32 s57, 256
    s_mov_b64 exec, s[58:59]
    v_mad_u32_u24 v20, v8, s56, v45
    v_mul_u32_u24 v91, s62, v8
    v_lshrrev_b32 v20, 24, v20
    v_lshrrev_b32 v91, 23, v91
    v_min_u32 v20, v20, v91
    v_lshl_add_u32 v91, v20, 2, s60
    ds_add_rtn_u32 v24, v91, v90
    v_mad_u32_u24 v21, v9, s56, v45
    v_mul_u32_u24 v91, s62, v9
    v_lshrrev_b32 v21, 24, v21
    v_lshrrev_b32 v91, 23, v91
    v_min_u32 v21, v21, v91
    v_lshl_add_u32 v91, v21, 2, s60
    ds_add_rtn_u32 v25, v91, v90
    v_mad_u32_u24 v22, v10, s56, v45
    v_mul_u32_u24 v91, s62, v10
    v_lshrrev_b32 v22, 24, v22
    v_lshrrev_b32 v91, 23, v91
    v_min_u32 v22, v22, v91
    v_lshl_add_u32 v91, v22, 2, s60
    ds_add_rtn_u32 v26, v91, v90
    v_mad_u32_u24 v23, v11, s56, v45
    v_mul_u32_u24 v91, s62, v11
    v_lshrrev_b32 v23, 24, v23
    v_lshrrev_b32 v91, 23, v91
    v_min_u32 v23, v23, v91
    v_lshl_add_u32 v91, v23, 2, s60
    ds_add_rtn_u32 v27, v91, v90
    v_lshl_or_b32 v28, v12, 14, v8
    v_and_b32 v88, 7, v20
    v_lshl_add_u32 v8, v20, 8, s61
    v_lshl_or_b32 v8, v88, 4, v8
    v_lshl_or_b32 v29, v13, 14, v9
    v_and_b32 v88, 7, v21
    v_lshl_add_u32 v9, v21, 8, s61
    v_lshl_or_b32 v9, v88, 4, v9
    v_lshl_or_b32 v30, v14, 14, v10
    v_and_b32 v88, 7, v22
    v_lshl_add_u32 v10, v22, 8, s61
    v_lshl_or_b32 v10, v88, 4, v10
    v_lshl_or_b32 v31, v15, 14, v11
    v_and_b32 v88, 7, v23
    v_lshl_add_u32 v11, v23, 8, s61
    v_lshl_or_b32 v11, v88, 4, v11
    v_lshrrev_b32 v18, 16, v16
    v_lshrrev_b32 v19, 16, v17
    s_waitcnt lgkmcnt(0)
    v_max3_u32 v87, v24, v25, v26
    v_max_u32 v87, v87, v27
    v_cmp_le_u32 vcc, 28, v87
    v_mad_u32_u24 v12, v24, 37, s57
    v_lshrrev_b32 v12, 8, v12
    v_add_lshl_u32 v12, v12, v24, 3
    v_xor_b32 v8, v12, v8
    v_mad_u32_u24 v13, v25, 37, s57
    v_lshrrev_b32 v13, 8, v13
    v_add_lshl_u32 v13, v13, v25, 3
    v_xor_b32 v9, v13, v9
    v_mad_u32_u24 v14, v26, 37, s57
    v_lshrrev_b32 v14, 8, v14
    v_add_lshl_u32 v14, v14, v26, 3
    v_xor_b32 v10, v14, v10
    v_mad_u32_u24 v15, v27, 37, s57
    v_lshrrev_b32 v15, 8, v15
    v_add_lshl_u32 v15, v15, v27, 3
    v_xor_b32 v11, v15, v11
    s_cbranch_vccnz F_ovf
    ds_write2_b32 v8, v28, v16 offset0:0 offset1:1
    ds_write2_b32 v9, v29, v18 offset0:0 offset1:1
    ds_write2_b32 v10, v30, v17 offset0:0 offset1:1
    ds_write2_b32 v11, v31, v19 offset0:0 offset1:1
F_ovfback:
    s_mov_b64 exec, -1
    s_add_u32 m0, s68, 0
    s_add_u32 s69, s68, 0
    buffer_load_dwordx4 v38, s[44:47], s69 offen lds
    s_add_u32 m0, s68, 16384
    s_add_u32 s69, s68, 16384
    buffer_load_dwordx4 v38, s[44:47], s69 offen lds
    s_waitcnt lgkmcnt(0)
    s_barrier
    ds_read2st64_b32 v[28:29], v42 offset0:0 offset1:2
    ds_read_b128 v[8:11], v40
    ds_read_b128 v[12:15], v40 offset:32768
    ds_read_b128 v[16:19], v40 offset:128
    ds_read_b128 v[20:23], v40 offset:32896
    ds_read_b32 v30, v44
    s_add_u32 m0, s68, 32768
    s_add_u32 s69, s68, 32768
    buffer_load_dwordx4 v38, s[44:47], s69 offen lds
    s_add_u32 m0, s68, 49152
    s_add_u32 s69, s68, 49152
    buffer_load_dwordx4 v38, s[44:47], s69 offen lds
    s_waitcnt vmcnt(6)
    s_mov_b32 s77, 0
F_tgb:
    v_readfirstlane_b32 s100, v92
    v_readfirstlane_b32 s101, v93
    s_add_u32 s77, s77, 1
    s_cmp_ge_u32 s77, 0x10000
    s_cbranch_scc1 F_thb
    s_cmp_lt_u32 s77, 0x100
    s_cselect_b32 s76, s65, s100
    s_sub_u32 s76, s100, s76
    s_cmp_lg_u32 s100, 0
    s_cselect_b32 s76, s76, -1
    s_cmp_ge_i32 s76, 0
    s_cbranch_scc1 F_thb
    buffer_load_dwordx2 v[92:93], v76, s[96:99], 0 offen sc1
    s_waitcnt vmcnt(0)
    s_branch F_tgb
F_thb:
    v_mov_b32 v31, s100
    s_waitcnt lgkmcnt(5)
    v_cmp_lt_u32 vcc, 14, v28
    v_min_u32 v28, 28, v28
    v_cmp_lt_u32 s[62:63], 14, v29
    v_min_u32 v29, 28, v29
    v_cndmask_b32 v24, v43, v41, vcc
    v_cndmask_b32 v25, v43, v41, s[62:63]
    s_waitcnt lgkmcnt(4)
    v_cndmask_b32 v8, v8, v28, s[22:23]
    v_cndmask_b32 v9, v9, v31, s[22:23]
    buffer_store_dwordx4 v[8:11], v41, s[32:35], s24 offen sc1
    s_waitcnt lgkmcnt(3)
    v_cndmask_b32 v12, v12, v29, s[22:23]
    v_cndmask_b32 v13, v13, v31, s[22:23]
    buffer_store_dwordx4 v[12:15], v41, s[32:35], s25 offen sc1
    s_waitcnt lgkmcnt(2)
    v_cndmask_b32 v17, v17, v31, s[22:23]
    buffer_store_dwordx4 v[16:19], v24, s[32:35], s24 offen offset:128 sc1
    s_waitcnt lgkmcnt(1)
    v_cndmask_b32 v21, v21, v31, s[22:23]
    buffer_store_dwordx4 v[20:23], v25, s[32:35], s25 offen offset:128 sc1
    s_cmp_lg_u32 s3, 0
    s_cbranch_scc1 F_bc1
    s_lshl_b32 s50, s2, 3
    s_add_u32 s50, s50, 5636096
    s_mov_b64 exec, 1
    s_waitcnt lgkmcnt(0)
    buffer_store_dwordx2 v[30:31], v76, s[32:35], s50 offen sc1
    s_mov_b64 exec, -1
F_bc1:
F_nbr:
    s_cmp_lt_u32 s2, 64
    s_cbranch_scc1 F_wc0
    s_waitcnt vmcnt(3)
    s_cmp_lt_u32 s48, 16
    s_cbranch_scc1 F_wc0
    s_waitcnt vmcnt(3)
F_wc0:
    s_waitcnt vmcnt(7) lgkmcnt(0)
    s_barrier
    buffer_load_dwordx2 v[60:61], v76, s[96:99], 0 offen sc1
    ds_read_b64_tr_b16 v[106:107], v36 offset:0
    ds_read_b64_tr_b16 v[108:109], v36 offset:2048
    ds_read_b128 v[94:97], v80 offset:0
    ds_read_b128 v[98:101], v80 offset:8192
    ds_read_b128 v[102:105], v80 offset:16384
    s_cmp_ge_u32 s48, 16
    s_cbranch_scc1 F_d0
    ds_read_b64_tr_b16 v[4:5], v83
    ds_read_b64_tr_b16 v[6:7], v83 offset:2048
    s_lshl_b32 s50, s3, 13
    s_and_b32 s49, s48, 7
    s_lshl_b32 s49, s49, 10
    s_add_u32 s50, s50, s49
    s_lshr_b32 s49, s48, 3
    s_lshl_b32 s49, s49, 17
    s_add_u32 s50, s50, s49
    s_add_u32 s50, s50, 5242880
    v_lshlrev_b32 v12, 4, v1
    s_waitcnt lgkmcnt(0)
    buffer_store_dwordx4 v[4:7], v12, s[32:35], s50 offen sc1
F_d0:
    s_cmp_lt_u32 s2, 64
    s_cbranch_scc1 F_wc1
    s_waitcnt vmcnt(4)
    s_cmp_lt_u32 s48, 16
    s_cbranch_scc1 F_wc1
    s_waitcnt vmcnt(3)
F_wc1:
    s_waitcnt vmcnt(7) lgkmcnt(0)
    s_barrier
    v_xor_b32 v93, 64, v80
    v_mfma_f32_16x16x32_bf16 v[64:67], v[106:109], v[94:97], 0
    ds_read_b64_tr_b16 v[122:123], v36 offset:16384
    ds_read_b64_tr_b16 v[124:125], v36 offset:18432
    v_mfma_f32_16x16x32_bf16 v[68:71], v[106:109], v[98:101], 0
    ds_read_b128 v[110:113], v93 offset:0
    v_mfma_f32_16x16x32_bf16 v[72:75], v[106:109], v[102:105], 0
    ds_read_b128 v[114:117], v93 offset:8192
    ds_read_b128 v[118:121], v93 offset:16384
    s_add_u32 m0, s68, 0
    s_add_u32 s69, s68, 65536
    buffer_load_dwordx4 v38, s[44:47], s69 offen lds
    s_cmp_lt_u32 s2, 64
    s_cbranch_scc1 F_wc2
    s_waitcnt vmcnt(4)
    s_cmp_lt_u32 s48, 16
    s_cbranch_scc1 F_wc2
    s_waitcnt vmcnt(3)
F_wc2:
    s_waitcnt vmcnt(7) lgkmcnt(0)
    s_barrier
    v_xor_b32 v93, 128, v80
    v_mfma_f32_16x16x32_bf16 v[64:67], v[122:125], v[110:113], v[64:67]
    ds_read_b64_tr_b16 v[106:107], v36 offset:32768
    ds_read_b64_tr_b16 v[108:109], v36 offset:34816
    v_mfma_f32_16x16x32_bf16 v[68:71], v[122:125], v[114:117], v[68:71]
    ds_read_b128 v[94:97], v93 offset:0
    v_mfma_f32_16x16x32_bf16 v[72:75], v[122:125], v[118:121], v[72:75]
    ds_read_b128 v[98:101], v93 offset:8192
    ds_read_b128 v[102:105], v93 offset:16384
    s_add_u32 m0, s68, 16384
    s_add_u32 s69, s68, 81920
    buffer_load_dwordx4 v38, s[44:47], s69 offen lds
    s_cmp_lt_u32 s2, 64
    s_cbranch_scc1 F_wc3
    s_waitcnt vmcnt(4)
    s_cmp_lt_u32 s48, 16
    s_cbranch_scc1 F_wc3
    s_waitcnt vmcnt(3)
F_wc3:
    s_waitcnt vmcnt(7) lgkmcnt(0)
    s_barrier
    v_xor_b32 v93, 192, v80
    v_mfma_f32_16x16x32_bf16 v[64:67], v[106:109], v[94:97], v[64:67]
    ds_read_b64_tr_b16 v[122:123], v36 offset:49152
    ds_read_b64_tr_b16 v[124:125], v36 offset:51200
    v_mfma_f32_16x16x32_bf16 v[68:71], v[106:109], v[98:101], v[68:71]
    ds_read_b128 v[110:113], v93 offset:0
    v_mfma_f32_16x16x32_bf16 v[72:75], v[106:109], v[102:105], v[72:75]
    ds_read_b128 v[114:117], v93 offset:8192
    ds_read_b128 v[118:121], v93 offset:16384
    s_add_u32 m0, s68, 32768
    s_add_u32 s69, s68, 98304
    buffer_load_dwordx4 v38, s[44:47], s69 offen lds
    s_waitcnt vmcnt(2) lgkmcnt(0)
    s_barrier
    v_xor_b32 v93, 256, v80
    v_mfma_f32_16x16x32_bf16 v[64:67], v[122:125], v[110:113], v[64:67]
    ds_read_b64_tr_b16 v[106:107], v36 offset:0
    ds_read_b64_tr_b16 v[108:109], v36 offset:2048
    v_mfma_f32_16x16x32_bf16 v[68:71], v[122:125], v[114:117], v[68:71]
    ds_read_b128 v[94:97], v93 offset:0
    v_mfma_f32_16x16x32_bf16 v[72:75], v[122:125], v[118:121], v[72:75]
    ds_read_b128 v[98:101], v93 offset:8192
    ds_read_b128 v[102:105], v93 offset:16384
    s_add_u32 m0, s68, 49152
    s_add_u32 s69, s68, 114688
    buffer_load_dwordx4 v38, s[44:47], s69 offen lds
    s_cmp_ge_u32 s48, 16
    s_cbranch_scc1 F_d5
    s_cmp_lg_u32 s3, 0
    s_cbranch_scc1 F_d5
    v_mov_b64 v[92:93], v[60:61]
    s_mov_b32 s77, 0
F_tgp:
    v_readfirstlane_b32 s100, v92
    v_readfirstlane_b32 s101, v93
    s_add_u32 s77, s77, 1
    s_cmp_ge_u32 s77, 0x10000
    s_cbranch_scc1 F_thp
    s_cmp_lt_u32 s77, 0x100
    s_cselect_b32 s76, s65, s100
    s_sub_u32 s76, s100, s76
    s_cmp_lg_u32 s100, 0
    s_cselect_b32 s76, s76, -1
    s_cmp_ge_i32 s76, 0
    s_cbranch_scc1 F_thp
    buffer_load_dwordx2 v[92:93], v76, s[96:99], 0 offen sc1
    s_waitcnt vmcnt(0)
    s_branch F_tgp
F_thp:
    s_lshl_b32 s76, s48, 7
    s_add_u32 s76, s76, 7241728
    v_mov_b32 v88, s100
    v_mov_b32 v89, s101
    s_mov_b64 exec, 1
    buffer_store_dwordx2 v[88:89], v76, s[32:35], s76 offen sc1
    s_mov_b64 exec, -1
F_d5:
    s_waitcnt vmcnt(2) lgkmcnt(0)
    s_barrier
    v_xor_b32 v93, 320, v80
    v_mfma_f32_16x16x32_bf16 v[64:67], v[106:109], v[94:97], v[64:67]
    ds_read_b64_tr_b16 v[122:123], v36 offset:16384
    ds_read_b64_tr_b16 v[124:125], v36 offset:18432
    v_mfma_f32_16x16x32_bf16 v[68:71], v[106:109], v[98:101], v[68:71]
    ds_read_b128 v[110:113], v93 offset:0
    v_mfma_f32_16x16x32_bf16 v[72:75], v[106:109], v[102:105], v[72:75]
    ds_read_b128 v[114:117], v93 offset:8192
    ds_read_b128 v[118:121], v93 offset:16384
    s_add_u32 m0, s68, 65536
    s_add_u32 s69, s68, 131072
    buffer_load_dwordx4 v38, s[44:47], s69 offen lds
    s_waitcnt vmcnt(2) lgkmcnt(0)
    s_barrier
    v_xor_b32 v93, 384, v80
    v_mfma_f32_16x16x32_bf16 v[64:67], v[122:125], v[110:113], v[64:67]
    ds_read_b64_tr_b16 v[106:107], v36 offset:32768
    ds_read_b64_tr_b16 v[108:109], v36 offset:34816
    v_mfma_f32_16x16x32_bf16 v[68:71], v[122:125], v[114:117], v[68:71]
    ds_read_b128 v[94:97], v93 offset:0
    v_mfma_f32_16x16x32_bf16 v[72:75], v[122:125], v[118:121], v[72:75]
    ds_read_b128 v[98:101], v93 offset:8192
    ds_read_b128 v[102:105], v93 offset:16384
    s_add_u32 m0, s68, 81920
    s_add_u32 s69, s68, 147456
    buffer_load_dwordx4 v38, s[44:47], s69 offen lds
    s_waitcnt vmcnt(2) lgkmcnt(0)
    s_barrier
    v_xor_b32 v93, 448, v80
    v_mfma_f32_16x16x32_bf16 v[64:67], v[106:109], v[94:97], v[64:67]
    ds_read_b64_tr_b16 v[122:123], v36 offset:49152
    ds_read_b64_tr_b16 v[124:125], v36 offset:51200
    v_mfma_f32_16x16x32_bf16 v[68:71], v[106:109], v[98:101], v[68:71]
    ds_read_b128 v[110:113], v93 offset:0
    v_mfma_f32_16x16x32_bf16 v[72:75], v[106:109], v[102:105], v[72:75]
    ds_read_b128 v[114:117], v93 offset:8192
    ds_read_b128 v[118:121], v93 offset:16384
    s_add_u32 m0, s68, 98304
    s_add_u32 s69, s68, 163840
    buffer_load_dwordx4 v38, s[44:47], s69 offen lds
    s_waitcnt lgkmcnt(0)
    s_barrier
    v_mfma_f32_16x16x32_bf16 v[64:67], v[122:125], v[110:113], v[64:67]
    v_mfma_f32_16x16x32_bf16 v[68:71], v[122:125], v[114:117], v[68:71]
    v_mfma_f32_16x16x32_bf16 v[72:75], v[122:125], v[118:121], v[72:75]
    s_add_u32 m0, s68, 114688
    s_add_u32 s69, s68, 180224
    buffer_load_dwordx4 v38, s[44:47], s69 offen lds
    s_lshl_b32 s78, s4, 9
    s_add_u32 s54, s78, 8192
    s_nop 0
    v_pk_mul_f32 v[64:65], v[64:65], s[74:75]
    v_pk_mul_f32 v[66:67], v[66:67], s[74:75]
    v_cvt_pk_bf16_f32 v40, v64, v65
    v_cvt_pk_bf16_f32 v41, v66, v67
    ds_write_b64 v84, v[40:41] offset:0
    v_pk_mul_f32 v[68:69], v[68:69], s[74:75]
    v_pk_mul_f32 v[70:71], v[70:71], s[74:75]
    v_cvt_pk_bf16_f32 v42, v68, v69
    v_cvt_pk_bf16_f32 v43, v70, v71
    ds_write_b64 v84, v[42:43] offset:8192
    v_pk_mul_f32 v[72:73], v[72:73], s[74:75]
    v_pk_mul_f32 v[74:75], v[74:75], s[74:75]
    v_cvt_pk_bf16_f32 v44, v72, v73
    v_cvt_pk_bf16_f32 v45, v74, v75
    ds_write_b64 v84, v[44:45] offset:16384
    s_lshl_b32 s59, s2, 14
    s_add_u32 s59, s59, 7340032
    s_mov_b32 s58, 7241728
    v_lshlrev_b32 v16, 7, v1
    v_min_u32 v16, 1920, v16
    s_cmp_lt_u32 s3, 8
    s_waitcnt lgkmcnt(0)
    s_barrier
    s_cbranch_scc0 F_nps
    ds_read_b128 v[64:67], v78
    ds_read_b128 v[68:71], v78 offset:8192
    ds_read_b128 v[72:75], v78 offset:16384
    s_waitcnt lgkmcnt(2)
    buffer_store_dwordx4 v[64:67], v2, s[8:11], s78 offen sc1
    s_waitcnt lgkmcnt(1)
    buffer_store_dwordx4 v[68:71], v2, s[8:11], s54 offen sc1
    s_waitcnt lgkmcnt(0)
    buffer_store_dwordx4 v[72:75], v82, s[8:11], s78 offen sc1
    buffer_load_dwordx4 v[40:43], v2, s[32:35], s59 offen sc1
    s_waitcnt vmcnt(4)
    s_branch F_ps2
F_nps:
    s_waitcnt vmcnt(0)
    s_cmp_lg_u32 s3, 15
    s_cbranch_scc1 F_npk0
    buffer_load_dwordx2 v[24:25], v16, s[32:35], s58 offen sc1
F_npk0:
    buffer_load_dwordx4 v[40:43], v2, s[32:35], s59 offen sc1
F_ps2:
    s_barrier
    ds_read_b64_tr_b16 v[106:107], v83 offset:0
    ds_read_b64_tr_b16 v[108:109], v83 offset:2048
    ds_read_b128 v[94:97], v80 offset:0
    ds_read_b128 v[98:101], v80 offset:8192
    ds_read_b128 v[102:105], v80 offset:16384
    v_mov_b64 v[92:93], v[60:61]
    s_mov_b32 s77, 0
F_tgm:
    v_readfirstlane_b32 s100, v92
    v_readfirstlane_b32 s101, v93
    s_add_u32 s77, s77, 1
    s_cmp_ge_u32 s77, 0x10000
    s_cbranch_scc1 F_thm
    s_cmp_lt_u32 s77, 0x100
    s_cselect_b32 s76, s65, s100
    s_sub_u32 s76, s100, s76
    s_cmp_lg_u32 s100, 0
    s_cselect_b32 s76, s76, -1
    s_cmp_ge_i32 s76, 0
    s_cbranch_scc1 F_thm
    buffer_load_dwordx2 v[92:93], v76, s[96:99], 0 offen sc1
    s_waitcnt vmcnt(0)
    s_branch F_tgm
F_thm:
    s_waitcnt lgkmcnt(0)
    v_xor_b32 v93, 64, v80
    v_mfma_f32_16x16x32_bf16 v[48:51], v[106:109], v[94:97], 0
    ds_read_b64_tr_b16 v[122:123], v83 offset:16384
    ds_read_b64_tr_b16 v[124:125], v83 offset:18432
    v_mfma_f32_16x16x32_bf16 v[52:55], v[106:109], v[98:101], 0
    ds_read_b128 v[110:113], v93 offset:0
    v_mfma_f32_16x16x32_bf16 v[56:59], v[106:109], v[102:105], 0
    ds_read_b128 v[114:117], v93 offset:8192
    ds_read_b128 v[118:121], v93 offset:16384
    s_waitcnt lgkmcnt(0)
    v_xor_b32 v93, 128, v80
    v_mfma_f32_16x16x32_bf16 v[48:51], v[122:125], v[110:113], v[48:51]
    ds_read_b64_tr_b16 v[106:107], v83 offset:32768
    ds_read_b64_tr_b16 v[108:109], v83 offset:34816
    v_mfma_f32_16x16x32_bf16 v[52:55], v[122:125], v[114:117], v[52:55]
    ds_read_b128 v[94:97], v93 offset:0
    v_mfma_f32_16x16x32_bf16 v[56:59], v[122:125], v[118:121], v[56:59]
    ds_read_b128 v[98:101], v93 offset:8192
    ds_read_b128 v[102:105], v93 offset:16384
    s_waitcnt lgkmcnt(0)
    v_xor_b32 v93, 192, v80
    v_mfma_f32_16x16x32_bf16 v[48:51], v[106:109], v[94:97], v[48:51]
    ds_read_b64_tr_b16 v[122:123], v83 offset:49152
    ds_read_b64_tr_b16 v[124:125], v83 offset:51200
    v_mfma_f32_16x16x32_bf16 v[52:55], v[106:109], v[98:101], v[52:55]
    ds_read_b128 v[110:113], v93 offset:0
    v_mfma_f32_16x16x32_bf16 v[56:59], v[106:109], v[102:105], v[56:59]
    ds_read_b128 v[114:117], v93 offset:8192
    ds_read_b128 v[118:121], v93 offset:16384
    s_waitcnt lgkmcnt(0)
    v_mfma_f32_16x16x32_bf16 v[48:51], v[122:125], v[110:113], v[48:51]
    v_mfma_f32_16x16x32_bf16 v[52:55], v[122:125], v[114:117], v[52:55]
    v_mfma_f32_16x16x32_bf16 v[56:59], v[122:125], v[118:121], v[56:59]
    s_add_u32 m0, s68, 32768
    s_add_u32 s69, s68, 196608
    buffer_load_dwordx4 v38, s[44:47], s69 offen lds
    s_add_u32 m0, s68, 49152
    s_add_u32 s69, s68, 212992
    buffer_load_dwordx4 v38, s[44:47], s69 offen lds
    s_add_u32 m0, s68, 0
    s_add_u32 s69, s68, 229376
    buffer_load_dwordx4 v38, s[44:47], s69 offen lds
    s_add_u32 m0, s68, 16384
    s_add_u32 s69, s68, 245760
    buffer_load_dwordx4 v38, s[44:47], s69 offen lds
    v_mov_b64 v[44:45], 0
    v_mov_b64 v[46:47], 0
    v_add_u32 v78, 91136, v2
    v_add_u32 v82, 99392, v2
    s_lshl_b32 s12, s3, 13
    s_add_u32 s12, s12, 5242880
    s_add_u32 s13, s12, 4096
    v_lshlrev_b32 v86, 4, v1
    s_mov_b32 s78, 0
    s_waitcnt vmcnt(5)
    s_cmp_lg_u32 s3, 15
    s_cbranch_scc1 F_npk
    s_mov_b32 s77, 0
F_plk:
    v_cmp_ne_u64 vcc, s[100:101], v[24:25]
    s_add_u32 s77, s77, 1
    s_cmp_ge_u32 s77, 0x10000
    s_cbranch_scc1 F_npk
    s_nop 1
    s_cbranch_vccz F_npk
    buffer_load_dwordx2 v[24:25], v16, s[32:35], s58 offen sc1
    s_waitcnt vmcnt(0)
    s_branch F_plk
F_npk:
    s_barrier
    s_cmp_lg_u32 s3, 0
    s_cbranch_scc1 F_nfp
    s_lshl_b32 s76, s2, 7
    s_add_u32 s76, s76, 7208960
    v_mov_b32 v88, s100
    v_mov_b32 v89, s101
    s_mov_b64 exec, 1
    buffer_store_dwordx2 v[88:89], v76, s[32:35], s76 offen sc1
    s_mov_b64 exec, -1
F_nfp:
    v_mov_b32 v26, v86
    buffer_load_dwordx4 v[94:97], v26, s[32:35], s12 offen offset:0 sc1
    buffer_load_dwordx4 v[98:101], v26, s[32:35], s12 offen offset:1024 sc1
    ds_write_b128 v78, v[44:47]
    ds_write_b128 v82, v[44:47]
    ds_write_b128 v82, v[44:47] offset:16384
    ds_write_b128 v82, v[44:47] offset:16448
    s_mov_b32 s56, 0
    s_mov_b64 s[40:41], s[20:21]
    s_mov_b32 s42, 5120000
    s_waitcnt vmcnt(6)
F_cl:
    v_mov_b32_dpp v87, v41 row_newbcast:0 row_mask:0xf bank_mask:0xf
    v_mov_b32_dpp v88, v40 row_newbcast:0 row_mask:0xf bank_mask:0xf
    v_mov_b32_dpp v89, v41 quad_perm:[0,0,0,0] row_mask:0xf bank_mask:0xf
    v_cmp_eq_u32 vcc, s100, v87
    v_cmp_ne_u32 s[70:71], s100, v89
    s_add_u32 s78, s78, 1
    v_cndmask_b32 v88, 0, v88, vcc
    v_max_u32 v90, 1, v88
    v_cmp_lt_u32 vcc, v34, v90
    s_cmp_ge_u32 s78, 0x10000
    s_cbranch_scc1 F_cd
    s_and_b64 exec, vcc, s[70:71]
    s_cbranch_execz F_cd
    s_sleep 1
    buffer_load_dwordx4 v[40:43], v2, s[32:35], s59 offen sc1
    s_mov_b64 exec, -1
    s_waitcnt vmcnt(0)
    s_branch F_cl
F_cd:
    s_mov_b64 exec, -1
    v_cmp_gt_u32 s[60:61], v88, v37
    v_cmp_gt_u32 s[62:63], v88, v35
    s_lshl_b32 s76, s4, 2
    s_sub_u32 s76, 132352, s76
    v_and_b32 v87, 0x3fff, v40
    v_and_b32 v88, 0x3fff, v42
    v_mov_b32 v90, 1
    v_lshl_add_u32 v87, v87, 2, s76
    v_lshl_add_u32 v88, v88, 2, s76
    s_mov_b64 exec, s[60:61]
    ds_add_rtn_u32 v4, v87, v90
    s_mov_b64 exec, s[62:63]
    ds_add_rtn_u32 v5, v88, v90
    s_mov_b64 exec, -1
    v_add_u32 v91, 132352, v81
    v_lshrrev_b32 v40, 5, v40
    v_lshrrev_b32 v42, 5, v42
    buffer_load_dwordx4 v[102:105], v26, s[32:35], s12 offen offset:2048 sc1
    buffer_load_dwordx4 v[106:109], v26, s[32:35], s12 offen offset:3072 sc1
    buffer_load_dwordx4 v[110:113], v26, s[32:35], s13 offen offset:0 sc1
    s_waitcnt vmcnt(5) lgkmcnt(0)
    s_barrier
    v_xor_b32 v93, 256, v80
    ds_read_b64_tr_b16 v[20:21], v36 offset:32768
    ds_read_b64_tr_b16 v[22:23], v36 offset:34816
    ds_read_b128 v[8:11], v93 offset:0
    ds_read_b128 v[12:15], v93 offset:8192
    ds_read_b128 v[16:19], v93 offset:16384
    ds_read_b32 v89, v91
    v_and_b32 v40, 0x7ffe00, v40
    v_and_b32 v42, 0x7ffe00, v42
    s_mov_b32 s76, 91136
    s_mov_b32 s77, 99392
    s_waitcnt lgkmcnt(0)
    v_add_u32_dpp v86, v89, v89 row_shr:1 row_mask:0xf bank_mask:0xf bound_ctrl:0
    s_nop 1
    v_add_u32_dpp v86, v86, v86 row_shr:2 row_mask:0xf bank_mask:0xf bound_ctrl:0
    s_nop 1
    v_add_u32_dpp v86, v86, v86 row_shr:4 row_mask:0xf bank_mask:0xf bound_ctrl:0
    s_nop 1
    v_add_u32_dpp v86, v86, v86 row_shr:8 row_mask:0xf bank_mask:0xf bound_ctrl:0
    s_nop 1
    v_add_u32_dpp v86, v86, v86 row_bcast:15 row_mask:0xa bank_mask:0xf
    s_nop 1
    v_add_u32_dpp v86, v86, v86 row_bcast:31 row_mask:0xc bank_mask:0xf
    v_sub_u32 v90, v86, v89
    v_readlane_b32 s55, v86, 63
    ds_bpermute_b32 v87, v87, v90
    ds_bpermute_b32 v88, v88, v90
    s_nop 1
    s_add_u32 s27, s55, 15
    s_lshr_b32 s27, s27, 4
    s_mul_i32 s48, s27, s3
    s_add_u32 s49, s48, s27
    s_min_u32 s48, s48, s55
    s_min_u32 s49, s49, s55
    s_waitcnt lgkmcnt(0)
    v_add_u32 v87, v87, v4
    v_add_u32 v88, v88, v5
    v_lshl_add_u32 v89, v87, 2, s76
    v_lshl_add_u32 v90, v88, 2, s76
    v_lshl_add_u32 v87, v87, 4, s77
    v_lshl_add_u32 v88, v88, 4, s77
    s_mov_b64 exec, s[60:61]
    ds_write_b32 v89, v40
    ds_write_b16 v87, v41 offset:8
    ds_write_b16 v87, v41 offset:14
    s_mov_b64 exec, s[62:63]
    ds_write_b32 v90, v42
    ds_write_b16 v88, v43 offset:8
    ds_write_b16 v88, v43 offset:14
    s_mov_b64 exec, -1
    s_waitcnt lgkmcnt(0)
    v_xor_b32 v93, 320, v80
    v_mfma_f32_16x16x32_bf16 v[48:51], v[20:23], v[8:11], v[48:51]
    ds_read_b64_tr_b16 v[28:29], v36 offset:49152
    ds_read_b64_tr_b16 v[30:31], v36 offset:51200
    v_mfma_f32_16x16x32_bf16 v[52:55], v[20:23], v[12:15], v[52:55]
    ds_read_b128 v[64:67], v93 offset:0
    v_mfma_f32_16x16x32_bf16 v[56:59], v[20:23], v[16:19], v[56:59]
    ds_read_b128 v[68:71], v93 offset:8192
    ds_read_b128 v[72:75], v93 offset:16384
    s_waitcnt lgkmcnt(0)
    v_xor_b32 v93, 384, v80
    v_mfma_f32_16x16x32_bf16 v[48:51], v[28:31], v[64:67], v[48:51]
    ds_read_b64_tr_b16 v[20:21], v36 offset:0
    ds_read_b64_tr_b16 v[22:23], v36 offset:2048
    v_mfma_f32_16x16x32_bf16 v[52:55], v[28:31], v[68:71], v[52:55]
    ds_read_b128 v[8:11], v93 offset:0
    v_mfma_f32_16x16x32_bf16 v[56:59], v[28:31], v[72:75], v[56:59]
    ds_read_b128 v[12:15], v93 offset:8192
    ds_read_b128 v[16:19], v93 offset:16384
    s_waitcnt lgkmcnt(0)
    v_xor_b32 v93, 448, v80
    v_mfma_f32_16x16x32_bf16 v[48:51], v[20:23], v[8:11], v[48:51]
    ds_read_b64_tr_b16 v[28:29], v36 offset:16384
    ds_read_b64_tr_b16 v[30:31], v36 offset:18432
    v_mfma_f32_16x16x32_bf16 v[52:55], v[20:23], v[12:15], v[52:55]
    ds_read_b128 v[64:67], v93 offset:0
    v_mfma_f32_16x16x32_bf16 v[56:59], v[20:23], v[16:19], v[56:59]
    ds_read_b128 v[68:71], v93 offset:8192
    ds_read_b128 v[72:75], v93 offset:16384
    s_waitcnt lgkmcnt(0)
    v_mfma_f32_16x16x32_bf16 v[48:51], v[28:31], v[64:67], v[48:51]
    v_mfma_f32_16x16x32_bf16 v[52:55], v[28:31], v[68:71], v[52:55]
    v_mfma_f32_16x16x32_bf16 v[56:59], v[28:31], v[72:75], v[56:59]
    v_mov_b32 v83, v26
    v_lshlrev_b32 v87, 16, v62
    v_and_b32 v88, 0xffff0000, v62
    v_lshlrev_b32 v89, 16, v63
    v_and_b32 v90, 0xffff0000, v63
    v_mul_f32 v87, s74, v87
    v_mul_f32 v88, s74, v88
    v_mul_f32 v89, s74, v89
    v_mul_f32 v90, s74, v90
    v_cvt_pk_bf16_f32 v6, v87, v88
    v_cvt_pk_bf16_f32 v7, v89, v90
    v_add_u32 v78, 50176, v2
    v_mov_b64 v[28:29], v[32:33]
    v_mov_b64 v[10:11], v[6:7]
    v_mov_b64 v[14:15], v[6:7]
    v_mov_b64 v[18:19], v[6:7]
    v_mov_b64 v[22:23], v[6:7]
    v_mov_b64 v[26:27], v[6:7]
    v_pk_mul_f32 v[48:49], v[48:49], s[74:75]
    v_pk_mul_f32 v[50:51], v[50:51], s[74:75]
    v_pk_mul_f32 v[52:53], v[52:53], s[74:75]
    v_pk_mul_f32 v[54:55], v[54:55], s[74:75]
    v_pk_mul_f32 v[56:57], v[56:57], s[74:75]
    v_pk_mul_f32 v[58:59], v[58:59], s[74:75]
    s_lshl_b32 s58, s3, 13
    s_add_u32 s58, s58, 7208960
    v_lshlrev_b32 v87, 7, v1
    s_cmp_ge_u32 s3, 4
    s_cbranch_scc1 F_np1
    buffer_load_dwordx2 v[88:89], v87, s[32:35], s58 offen sc1
F_np1:
    s_barrier
    ds_write_b128 v79, v[48:51] offset:0
    ds_write_b128 v79, v[52:55] offset:16640
    ds_write_b128 v79, v[56:59] offset:33280
    ds_write_b128 v78, v[44:47]
    ds_write_b128 v78, v[44:47] offset:8192
    s_cmp_ge_u32 s3, 4
    s_cbranch_scc1 F_npp
    s_mov_b32 s77, 0
    s_waitcnt vmcnt(0)
F_plp:
    v_cmpx_ne_u64 vcc, s[100:101], v[88:89]
    s_add_u32 s77, s77, 1
    s_nop 3
    s_cbranch_execz F_pdp
    s_cmp_ge_u32 s77, 0x10000
    s_cbranch_scc1 F_pdp
    buffer_load_dwordx2 v[88:89], v87, s[32:35], s58 offen sc1
    s_waitcnt vmcnt(0)
    s_branch F_plp
F_pdp:
    s_mov_b64 exec, -1
F_npp:
    buffer_load_dwordx4 v[114:117], v83, s[32:35], s13 offen offset:1024 sc1
    buffer_load_dwordx4 v[118:121], v83, s[32:35], s13 offen offset:2048 sc1
    buffer_load_dwordx4 v[122:125], v83, s[32:35], s13 offen offset:3072 sc1
    s_mov_b32 s76, 5636096
    buffer_load_dwordx2 v[76:77], v85, s[32:35], s76 offen sc1
    s_waitcnt lgkmcnt(0)
    s_barrier
L_pr:
    v_mov_b32 v87, 0
    ds_write_b32 v91, v87
    s_lshl_b32 s76, s48, 2
    s_add_u32 s76, s76, 91136
    v_mov_b32 v82, s76
    s_lshl_b32 s76, s48, 4
    v_add_u32 v83, s76, v126
    ds_read2_b32 v[40:41], v82 offset0:0 offset1:1
    ds_read2_b32 v[42:43], v82 offset0:2 offset1:3
    ds_read2_b32 v[44:45], v82 offset0:4 offset1:5
    ds_read_b32 v79, v82 offset:24
    ds_read2_b32 v[30:31], v83 offset0:0 offset1:2
    ds_read2_b32 v[34:35], v83 offset0:4 offset1:6
    s_waitcnt lgkmcnt(0)
    buffer_load_dword v4, v40, s[16:19], 0 offen sc1
    buffer_load_dword v5, v40, s[16:19], 0 offen offset:256 sc1
    buffer_load_dword v8, v41, s[16:19], 0 offen sc1
    buffer_load_dword v9, v41, s[16:19], 0 offen offset:256 sc1
    buffer_load_dword v12, v42, s[16:19], 0 offen sc1
    buffer_load_dword v13, v42, s[16:19], 0 offen offset:256 sc1
    buffer_load_dword v16, v43, s[16:19], 0 offen sc1
    buffer_load_dword v17, v43, s[16:19], 0 offen offset:256 sc1
    buffer_load_dword v20, v44, s[16:19], 0 offen sc1
    buffer_load_dword v21, v44, s[16:19], 0 offen offset:256 sc1
    buffer_load_dword v24, v45, s[16:19], 0 offen sc1
    buffer_load_dword v25, v45, s[16:19], 0 offen offset:256 sc1
    s_cmp_lg_u32 s56, 0
    s_cbranch_scc1 L_go
    s_call_b64 s[66:67], L_ugemm
L_go:
    s_mov_b64 vcc, 0
    s_mov_b32 s54, 24
    s_add_u32 s56, s56, 1
    s_cmp_ge_u32 s48, s49
    s_cbranch_scc1 L_loopdone
    v_cmp_eq_u32 s[70:71], s48, v86
    s_sub_u32 s7, s49, s48
    s_add_u32 s7, s7, 5
    s_mul_i32 s7, s7, 171
    s_lshr_b32 s7, s7, 10
    s_cmp_eq_u32 s48, 0
    s_cselect_b32 s78, 1, 0
    s_cmp_lg_u64 s[70:71], 0
    s_cselect_b32 s78, 1, s78
    v_cmp_ge_u32 s[70:71], s48, v86
    s_xor_b32 s6, s78, 1
    s_xor_b32 s78, s26, 1
    s_lshl_b32 s78, s78, 2
    s_or_b32 s6, s6, s78
    s_bcnt1_i32_b64 s14, s[70:71]
    s_call_b64 s[66:67], L_node
    s_setprio 3
    v_mov_b64 v[52:53], 0
    v_mov_b64 v[54:55], 0
    v_mov_b64 v[56:57], s[72:73]
    v_mov_b64 v[58:59], s[72:73]
    s_waitcnt vmcnt(10) lgkmcnt(0)
    v_mfma_f32_16x16x32_bf16 v[40:43], v[28:31], v[4:7], v[36:39]
    s_nop 5
L_top:
    s_waitcnt vmcnt(8) lgkmcnt(0)
    v_mfma_f32_16x16x32_bf16 v[44:47], v[32:35], v[8:11], v[36:39]
    v_exp_f32 v48, v40
    v_exp_f32 v49, v41
    v_exp_f32 v50, v42
    v_exp_f32 v51, v43
    buffer_load_dword v4, v79, s[16:19], 0 offen sc1
    buffer_load_dword v5, v79, s[16:19], 0 offen offset:256 sc1
    ds_read_b32 v79, v82 offset:28
    ds_read2_b32 v[30:31], v83 offset0:8 offset1:10
    v_pk_fma_f32 v[52:53], v[52:53], v[48:49], v[52:53]
    v_pk_fma_f32 v[54:55], v[54:55], v[50:51], v[54:55]
    v_pk_fma_f32 v[52:53], v[40:41], v[56:57], v[52:53]
    v_pk_fma_f32 v[54:55], v[42:43], v[58:59], v[54:55]
    v_pk_fma_f32 v[56:57], v[56:57], v[48:49], v[56:57]
    v_pk_fma_f32 v[58:59], v[58:59], v[50:51], v[58:59]
    s_sub_u32 s50, s50, 1
    s_cbranch_scc1 L_call0
L_next0:
    s_waitcnt vmcnt(8) lgkmcnt(0)
    v_mfma_f32_16x16x32_bf16 v[40:43], v[28:31], v[12:15], v[36:39]
    v_exp_f32 v48, v44
    v_exp_f32 v49, v45
    v_exp_f32 v50, v46
    v_exp_f32 v51, v47
    buffer_load_dword v8, v79, s[16:19], 0 offen sc1
    buffer_load_dword v9, v79, s[16:19], 0 offen offset:256 sc1
    ds_read_b32 v79, v82 offset:32
    ds_read2_b32 v[34:35], v83 offset0:12 offset1:14
    v_pk_fma_f32 v[52:53], v[52:53], v[48:49], v[52:53]
    v_pk_fma_f32 v[54:55], v[54:55], v[50:51], v[54:55]
    v_pk_fma_f32 v[52:53], v[44:45], v[56:57], v[52:53]
    v_pk_fma_f32 v[54:55], v[46:47], v[58:59], v[54:55]
    v_pk_fma_f32 v[56:57], v[56:57], v[48:49], v[56:57]
    v_pk_fma_f32 v[58:59], v[58:59], v[50:51], v[58:59]
    s_sub_u32 s50, s50, 1
    s_cbranch_scc1 L_call1
L_next1:
    s_waitcnt vmcnt(8) lgkmcnt(0)
    v_mfma_f32_16x16x32_bf16 v[44:47], v[32:35], v[16:19], v[36:39]
    v_exp_f32 v48, v40
    v_exp_f32 v49, v41
    v_exp_f32 v50, v42
    v_exp_f32 v51, v43
    buffer_load_dword v12, v79, s[16:19], 0 offen sc1
    buffer_load_dword v13, v79, s[16:19], 0 offen offset:256 sc1
    ds_read_b32 v79, v82 offset:36
    ds_read2_b32 v[30:31], v83 offset0:16 offset1:18
    v_pk_fma_f32 v[52:53], v[52:53], v[48:49], v[52:53]
    v_pk_fma_f32 v[54:55], v[54:55], v[50:51], v[54:55]
    v_pk_fma_f32 v[52:53], v[40:41], v[56:57], v[52:53]
    v_pk_fma_f32 v[54:55], v[42:43], v[58:59], v[54:55]
    v_pk_fma_f32 v[56:57], v[56:57], v[48:49], v[56:57]
    v_pk_fma_f32 v[58:59], v[58:59], v[50:51], v[58:59]
    s_sub_u32 s50, s50, 1
    s_cbranch_scc1 L_call2
L_next2:
    s_waitcnt vmcnt(8) lgkmcnt(0)
    v_mfma_f32_16x16x32_bf16 v[40:43], v[28:31], v[20:23], v[36:39]
    v_exp_f32 v48, v44
    v_exp_f32 v49, v45
    v_exp_f32 v50, v46
    v_exp_f32 v51, v47
    buffer_load_dword v16, v79, s[16:19], 0 offen sc1
    buffer_load_dword v17, v79, s[16:19], 0 offen offset:256 sc1
    ds_read_b32 v79, v82 offset:40
    ds_read2_b32 v[34:35], v83 offset0:20 offset1:22
    v_pk_fma_f32 v[52:53], v[52:53], v[48:49], v[52:53]
    v_pk_fma_f32 v[54:55], v[54:55], v[50:51], v[54:55]
    v_pk_fma_f32 v[52:53], v[44:45], v[56:57], v[52:53]
    v_pk_fma_f32 v[54:55], v[46:47], v[58:59], v[54:55]
    v_pk_fma_f32 v[56:57], v[56:57], v[48:49], v[56:57]
    v_pk_fma_f32 v[58:59], v[58:59], v[50:51], v[58:59]
    s_sub_u32 s50, s50, 1
    s_cbranch_scc1 L_call3
L_next3:
    s_waitcnt vmcnt(8) lgkmcnt(0)
    v_mfma_f32_16x16x32_bf16 v[44:47], v[32:35], v[24:27], v[36:39]
    v_exp_f32 v48, v40
    v_exp_f32 v49, v41
    v_exp_f32 v50, v42
    v_exp_f32 v51, v43
    buffer_load_dword v20, v79, s[16:19], 0 offen sc1
    buffer_load_dword v21, v79, s[16:19], 0 offen offset:256 sc1
    ds_read_b32 v79, v82 offset:44
    ds_read2_b32 v[30:31], v83 offset0:24 offset1:26
    v_pk_fma_f32 v[52:53], v[52:53], v[48:49], v[52:53]
    v_pk_fma_f32 v[54:55], v[54:55], v[50:51], v[54:55]
    v_pk_fma_f32 v[52:53], v[40:41], v[56:57], v[52:53]
    v_pk_fma_f32 v[54:55], v[42:43], v[58:59], v[54:55]
    v_pk_fma_f32 v[56:57], v[56:57], v[48:49], v[56:57]
    v_pk_fma_f32 v[58:59], v[58:59], v[50:51], v[58:59]
    s_sub_u32 s50, s50, 1
    s_cbranch_scc1 L_call4
L_next4:
    s_waitcnt vmcnt(8) lgkmcnt(0)
    v_mfma_f32_16x16x32_bf16 v[40:43], v[28:31], v[4:7], v[36:39]
    v_exp_f32 v48, v44
    v_exp_f32 v49, v45
    v_exp_f32 v50, v46
    v_exp_f32 v51, v47
    buffer_load_dword v24, v79, s[16:19], 0 offen sc1
    buffer_load_dword v25, v79, s[16:19], 0 offen offset:256 sc1
    ds_read_b32 v79, v82 offset:48
    ds_read2_b32 v[34:35], v83 offset0:28 offset1:30
    v_pk_fma_f32 v[52:53], v[52:53], v[48:49], v[52:53]
    v_pk_fma_f32 v[54:55], v[54:55], v[50:51], v[54:55]
    v_pk_fma_f32 v[52:53], v[44:45], v[56:57], v[52:53]
    v_pk_fma_f32 v[54:55], v[46:47], v[58:59], v[54:55]
    v_pk_fma_f32 v[56:57], v[56:57], v[48:49], v[56:57]
    v_pk_fma_f32 v[58:59], v[58:59], v[50:51], v[58:59]
    s_sub_u32 s50, s50, 1
    s_cbranch_scc1 L_call5
L_next5:
    v_add_u32 v82, 24, v82
    v_add_u32 v83, 96, v83
    s_sub_u32 s7, s7, 1
    s_cmp_ge_u32 s7, 4
    s_cbranch_scc1 L_top
    s_setprio 2
    s_cmp_ge_u32 s7, 3
    s_cbranch_scc1 L_top
    s_setprio 1
    s_cmp_ge_u32 s7, 2
    s_cbranch_scc1 L_top
    s_setprio 0
    s_branch L_top
L_call0:
    s_call_b64 s[66:67], L_flush
    s_cbranch_scc0 L_special
    s_waitcnt lgkmcnt(0)
    v_mfma_f32_16x16x32_bf16 v[44:47], v[32:35], v[8:11], v[36:39]
    s_nop 5
    s_waitcnt vmcnt(8) lgkmcnt(0)
    v_mfma_f32_16x16x32_bf16 v[40:43], v[28:31], v[12:15], v[36:39]
    v_exp_f32 v48, v44
    v_exp_f32 v49, v45
    v_exp_f32 v50, v46
    v_exp_f32 v51, v47
    buffer_load_dword v8, v79, s[16:19], 0 offen sc1
    buffer_load_dword v9, v79, s[16:19], 0 offen offset:256 sc1
    ds_read_b32 v79, v82 offset:32
    ds_read2_b32 v[34:35], v83 offset0:12 offset1:14
    v_pk_add_f32 v[56:57], v[48:49], s[72:73]
    v_mov_b64 v[52:53], v[44:45]
    v_mov_b64 v[54:55], v[46:47]
    v_pk_add_f32 v[58:59], v[50:51], s[72:73]
    s_sub_u32 s50, s50, 1
    s_cbranch_scc1 L_call1
    s_branch L_next1
L_call1:
    s_call_b64 s[66:67], L_flush
    s_cbranch_scc0 L_special
    s_waitcnt lgkmcnt(0)
    v_mfma_f32_16x16x32_bf16 v[40:43], v[28:31], v[12:15], v[36:39]
    s_nop 5
    s_waitcnt vmcnt(8) lgkmcnt(0)
    v_mfma_f32_16x16x32_bf16 v[44:47], v[32:35], v[16:19], v[36:39]
    v_exp_f32 v48, v40
    v_exp_f32 v49, v41
    v_exp_f32 v50, v42
    v_exp_f32 v51, v43
    buffer_load_dword v12, v79, s[16:19], 0 offen sc1
    buffer_load_dword v13, v79, s[16:19], 0 offen offset:256 sc1
    ds_read_b32 v79, v82 offset:36
    ds_read2_b32 v[30:31], v83 offset0:16 offset1:18
    v_pk_add_f32 v[56:57], v[48:49], s[72:73]
    v_mov_b64 v[52:53], v[40:41]
    v_mov_b64 v[54:55], v[42:43]
    v_pk_add_f32 v[58:59], v[50:51], s[72:73]
    s_sub_u32 s50, s50, 1
    s_cbranch_scc1 L_call2
    s_branch L_next2
L_call2:
    s_call_b64 s[66:67], L_flush
    s_cbranch_scc0 L_special
    s_waitcnt lgkmcnt(0)
    v_mfma_f32_16x16x32_bf16 v[44:47], v[32:35], v[16:19], v[36:39]
    s_nop 5
    s_waitcnt vmcnt(8) lgkmcnt(0)
    v_mfma_f32_16x16x32_bf16 v[40:43], v[28:31], v[20:23], v[36:39]
    v_exp_f32 v48, v44
    v_exp_f32 v49, v45
    v_exp_f32 v50, v46
    v_exp_f32 v51, v47
    buffer_load_dword v16, v79, s[16:19], 0 offen sc1
    buffer_load_dword v17, v79, s[16:19], 0 offen offset:256 sc1
    ds_read_b32 v79, v82 offset:40
    ds_read2_b32 v[34:35], v83 offset0:20 offset1:22
    v_pk_add_f32 v[56:57], v[48:49], s[72:73]
    v_mov_b64 v[52:53], v[44:45]
    v_mov_b64 v[54:55], v[46:47]
    v_pk_add_f32 v[58:59], v[50:51], s[72:73]
    s_sub_u32 s50, s50, 1
    s_cbranch_scc1 L_call3
    s_branch L_next3
L_call3:
    s_call_b64 s[66:67], L_flush
    s_cbranch_scc0 L_special
    s_waitcnt lgkmcnt(0)
    v_mfma_f32_16x16x32_bf16 v[40:43], v[28:31], v[20:23], v[36:39]
    s_nop 5
    s_waitcnt vmcnt(8) lgkmcnt(0)
    v_mfma_f32_16x16x32_bf16 v[44:47], v[32:35], v[24:27], v[36:39]
    v_exp_f32 v48, v40
    v_exp_f32 v49, v41
    v_exp_f32 v50, v42
    v_exp_f32 v51, v43
    buffer_load_dword v20, v79, s[16:19], 0 offen sc1
    buffer_load_dword v21, v79, s[16:19], 0 offen offset:256 sc1
    ds_read_b32 v79, v82 offset:44
    ds_read2_b32 v[30:31], v83 offset0:24 offset1:26
    v_pk_add_f32 v[56:57], v[48:49], s[72:73]
    v_mov_b64 v[52:53], v[40:41]
    v_mov_b64 v[54:55], v[42:43]
    v_pk_add_f32 v[58:59], v[50:51], s[72:73]
    s_sub_u32 s50, s50, 1
    s_cbranch_scc1 L_call4
    s_branch L_next4
L_call4:
    s_call_b64 s[66:67], L_flush
    s_cbranch_scc0 L_special
    s_waitcnt lgkmcnt(0)
    v_mfma_f32_16x16x32_bf16 v[44:47], v[32:35], v[24:27], v[36:39]
    s_nop 5
    s_waitcnt vmcnt(8) lgkmcnt(0)
    v_mfma_f32_16x16x32_bf16 v[40:43], v[28:31], v[4:7], v[36:39]
    v_exp_f32 v48, v44
    v_exp_f32 v49, v45
    v_exp_f32 v50, v46
    v_exp_f32 v51, v47
    buffer_load_dword v24, v79, s[16:19], 0 offen sc1
    buffer_load_dword v25, v79, s[16:19], 0 offen offset:256 sc1
    ds_read_b32 v79, v82 offset:48
    ds_read2_b32 v[34:35], v83 offset0:28 offset1:30
    v_pk_add_f32 v[56:57], v[48:49], s[72:73]
    v_mov_b64 v[52:53], v[44:45]
    v_mov_b64 v[54:55], v[46:47]
    v_pk_add_f32 v[58:59], v[50:51], s[72:73]
    s_sub_u32 s50, s50, 1
    s_cbranch_scc1 L_call5
    s_branch L_next5
L_call5:
    s_call_b64 s[66:67], L_flush
    s_cbranch_scc0 L_special
    s_waitcnt lgkmcnt(0)
    v_mfma_f32_16x16x32_bf16 v[40:43], v[28:31], v[4:7], v[36:39]
    v_add_u32 v82, 24, v82
    v_add_u32 v83, 96, v83
    s_sub_u32 s7, s7, 1
    s_cmp_ge_u32 s7, 4
    s_cbranch_scc1 L_cb5
    s_setprio 2
    s_cmp_ge_u32 s7, 3
    s_cbranch_scc1 L_cb5
    s_setprio 1
    s_cmp_ge_u32 s7, 2
    s_cbranch_scc1 L_cb5
    s_setprio 0
L_cb5:
    s_nop 2
    s_waitcnt vmcnt(8) lgkmcnt(0)
    v_mfma_f32_16x16x32_bf16 v[44:47], v[32:35], v[8:11], v[36:39]
    v_exp_f32 v48, v40
    v_exp_f32 v49, v41
    v_exp_f32 v50, v42
    v_exp_f32 v51, v43
    buffer_load_dword v4, v79, s[16:19], 0 offen sc1
    buffer_load_dword v5, v79, s[16:19], 0 offen offset:256 sc1
    ds_read_b32 v79, v82 offset:28
    ds_read2_b32 v[30:31], v83 offset0:8 offset1:10
    v_pk_add_f32 v[56:57], v[48:49], s[72:73]
    v_mov_b64 v[52:53], v[40:41]
    v_mov_b64 v[54:55], v[42:43]
    v_pk_add_f32 v[58:59], v[50:51], s[72:73]
    s_sub_u32 s50, s50, 1
    s_cbranch_scc1 L_call0
    s_branch L_next0
L_flush:
    v_rcp_f32 v48, v56
    v_rcp_f32 v49, v57
    v_rcp_f32 v50, v58
    v_rcp_f32 v51, v59
    v_pk_fma_f32 v[88:89], v[52:53], 0, v[56:57]
    v_pk_fma_f32 v[90:91], v[54:55], 0, v[58:59]
    v_pk_mul_f32 v[52:53], v[52:53], v[48:49]
    v_pk_add_f32 v[88:89], v[88:89], v[90:91]
    v_pk_mul_f32 v[54:55], v[54:55], v[50:51]
    v_add_f32 v88, v88, v89
    v_cmp_nle_f32 s[70:71], v88, s79
    v_cvt_pk_bf16_f32 v48, v52, v53
    v_cvt_pk_bf16_f32 v49, v54, v55
    s_mov_b32 s48, s51
    s_sub_u32 s76, s53, s48
    s_or_b32 s76, s76, s6
    s_andn2_b64 s[70:71], s[70:71], vcc
    s_cbranch_scc1 L_bad
    s_cmp_lg_u32 s76, 0
    s_cbranch_scc1 L_odd
    ds_write2st64_b32 v78, v48, v49 offset0:0 offset1:1
L_more:
    s_cmp_eq_u32 s48, s49
    s_cbranch_scc1 L_done
L_adv:
    s_add_u32 s14, s14, 1
L_node:
    s_mul_i32 s77, s14, 1040
    v_readlane_b32 s53, v86, s14
    v_add_u32 v84, s77, v85
    s_and_b32 s77, s14, 15
    s_lshl_b32 s77, s77, 4
    s_lshl_b32 s76, s14, 9
    s_cmp_eq_u32 s53, s48
    s_cbranch_scc1 L_adv
    ds_read2st64_b64 v[36:39], v84 offset0:0 offset1:1
    s_or_b32 s76, s76, s77
    s_add_u32 s76, s76, 50176
    v_xor_b32 v78, s76, v81
    s_cmp_lg_u32 s56, 1
    s_cbranch_scc1 L_old
L_reinit:
    s_mov_b32 s52, s48
    s_add_u32 s51, s48, s54
    s_min_u32 s51, s51, s53
    s_min_u32 s51, s51, s49
    s_not_b32 s50, s48
    s_add_u32 s50, s50, s51
    s_cmp_eq_u32 s48, s48
    s_setpc_b64 s[66:67]
L_done:
    s_cmp_lg_u32 s48, s48
    s_setpc_b64 s[66:67]
L_bad:
    s_mov_b32 s48, s52
    s_branch L_done
L_odd:
    s_bitcmp1_b32 s6, 2
    s_cbranch_scc0 L_havew
    s_bitset0_b32 s6, 2
    s_mov_b32 s26, 1
    s_lshl_b32 s76, s3, 13
    s_add_u32 s76, s76, 5373952
    s_add_u32 s77, s76, 4096
    v_lshlrev_b32 v92, 4, v1
    buffer_load_dwordx4 v[94:97], v92, s[32:35], s76 offen offset:0 sc1
    buffer_load_dwordx4 v[98:101], v92, s[32:35], s76 offen offset:1024 sc1
    buffer_load_dwordx4 v[102:105], v92, s[32:35], s76 offen offset:2048 sc1
    buffer_load_dwordx4 v[106:109], v92, s[32:35], s76 offen offset:3072 sc1
    buffer_load_dwordx4 v[110:113], v92, s[32:35], s77 offen offset:0 sc1
    buffer_load_dwordx4 v[114:117], v92, s[32:35], s77 offen offset:1024 sc1
    buffer_load_dwordx4 v[118:121], v92, s[32:35], s77 offen offset:2048 sc1
    buffer_load_dwordx4 v[122:125], v92, s[32:35], s77 offen offset:3072 sc1
L_havew:
    s_bitcmp1_b32 s6, 1
    s_cbranch_scc0 L_noac
    v_pk_add_f32 v[52:53], v[52:53], v[60:61]
    v_pk_add_f32 v[54:55], v[54:55], v[62:63]
    s_bitset0_b32 s6, 1
L_noac:
    s_cmp_eq_u32 s48, s53
    s_cbranch_scc1 L_fin
    s_cmp_eq_u32 s48, s49
    s_cbranch_scc1 L_tail
    v_mov_b64 v[60:61], v[52:53]
    v_mov_b64 v[62:63], v[54:55]
    s_bitset1_b32 s6, 1
    s_branch L_reinit
L_tail:
    s_bitcmp1_b32 s6, 0
    s_cbranch_scc1 L_pub
    s_mov_b32 s76, s3
    s_mov_b32 s77, s49
L_col:
    s_add_u32 s76, s76, 1
    s_lshl_b32 s78, s76, 2
    s_add_u32 s78, s78, 132608
    v_mov_b32 v88, s78
L_poll:
    ds_read_b32 v89, v88
    s_waitcnt lgkmcnt(0)
    v_readfirstlane_b32 s78, v89
    s_nop 3
    s_cmp_eq_u32 s78, s56
    s_cbranch_scc1 L_got
    s_sleep 1
    s_branch L_poll
L_got:
    s_lshl_b32 s78, s76, 10
    s_add_u32 s78, s78, 74752
    v_add_u32 v88, s78, v85
    ds_read2st64_b64 v[48:51], v88 offset0:0 offset1:1
    s_add_u32 s77, s77, s27
    s_waitcnt lgkmcnt(0)
    v_pk_add_f32 v[52:53], v[52:53], v[48:49]
    v_pk_add_f32 v[54:55], v[54:55], v[50:51]
    s_cmp_lt_u32 s77, s53
    s_cbranch_scc1 L_col
    s_branch L_wr
L_fin:
    s_bitcmp1_b32 s6, 0
    s_cbranch_scc1 L_pub
L_wr:
    v_cvt_pk_bf16_f32 v48, v52, v53
    v_cvt_pk_bf16_f32 v49, v54, v55
    ds_write2st64_b32 v78, v48, v49 offset0:0 offset1:1
    s_branch L_more
L_pub:
    s_lshl_b32 s78, s3, 10
    s_add_u32 s78, s78, 74752
    v_add_u32 v88, s78, v85
    s_lshl_b32 s78, s3, 2
    s_add_u32 s78, s78, 132608
    v_mov_b32 v89, s78
    v_mov_b32 v90, s56
    ds_write2st64_b64 v88, v[52:53], v[54:55] offset0:0 offset1:1
    s_bitset0_b32 s6, 0
    s_waitcnt lgkmcnt(0)
    ds_write_b32 v89, v90
    s_branch L_more
L_old:
    s_bitcmp1_b32 s6, 0
    s_cbranch_scc1 L_reinit
    ds_read2st64_b32 v[48:49], v78 offset0:0 offset1:1
    s_bitset1_b32 s6, 1
    s_waitcnt lgkmcnt(0)
    v_lshlrev_b32 v60, 16, v48
    v_and_b32 v61, 0xffff0000, v48
    v_lshlrev_b32 v62, 16, v49
    v_and_b32 v63, 0xffff0000, v49
    s_branch L_reinit
L_special:
    s_cmp_eq_u32 s48, s49
    s_cbranch_scc1 L_loopdone
    s_mov_b64 vcc, -1
    s_mov_b32 s54, 1
    s_waitcnt vmcnt(0) lgkmcnt(0)
    s_call_b64 s[66:67], L_reinit
L_slow:
    v_mov_b64 v[52:53], 0
    v_mov_b64 v[54:55], 0
    v_mov_b64 v[56:57], s[72:73]
    v_mov_b64 v[58:59], s[72:73]
    s_lshl_b32 s76, s48, 2
    s_add_u32 s76, s76, 91136
    v_mov_b32 v82, s76
    s_lshl_b32 s76, s48, 4
    v_add_u32 v83, s76, v126
    ds_read_b32 v79, v82
    ds_read2_b32 v[30:31], v83 offset0:0 offset1:2
    s_waitcnt lgkmcnt(0)
    buffer_load_dword v4, v79, s[16:19], 0 offen sc1
    buffer_load_dword v5, v79, s[16:19], 0 offen offset:256 sc1
    s_waitcnt vmcnt(0)
    v_mfma_f32_16x16x32_bf16 v[40:43], v[28:31], v[4:7], v[36:39]
    s_nop 7
    v_min_f32 v40, 0x42fc0000, v40
    v_min_f32 v41, 0x42fc0000, v41
    v_min_f32 v42, 0x42fc0000, v42
    v_min_f32 v43, 0x42fc0000, v43
    v_exp_f32 v48, v40
    v_exp_f32 v49, v41
    v_exp_f32 v50, v42
    v_exp_f32 v51, v43
    v_pk_fma_f32 v[52:53], v[52:53], v[48:49], v[52:53]
    v_pk_fma_f32 v[54:55], v[54:55], v[50:51], v[54:55]
    v_pk_fma_f32 v[52:53], v[40:41], v[56:57], v[52:53]
    v_pk_fma_f32 v[54:55], v[42:43], v[58:59], v[54:55]
    v_pk_fma_f32 v[56:57], v[56:57], v[48:49], v[56:57]
    v_pk_fma_f32 v[58:59], v[58:59], v[50:51], v[58:59]
    s_call_b64 s[66:67], L_flush
    s_cbranch_scc1 L_slow
L_loopdone:
    s_setprio 0
    s_cmp_lg_u32 s26, 0
    s_cbranch_scc1 L_ld2
    s_mov_b32 s26, 1
    s_lshl_b32 s76, s3, 13
    s_add_u32 s76, s76, 5373952
    s_add_u32 s77, s76, 4096
    v_lshlrev_b32 v92, 4, v1
    buffer_load_dwordx4 v[94:97], v92, s[32:35], s76 offen offset:0 sc1
    buffer_load_dwordx4 v[98:101], v92, s[32:35], s76 offen offset:1024 sc1
    buffer_load_dwordx4 v[102:105], v92, s[32:35], s76 offen offset:2048 sc1
    buffer_load_dwordx4 v[106:109], v92, s[32:35], s76 offen offset:3072 sc1
    buffer_load_dwordx4 v[110:113], v92, s[32:35], s77 offen offset:0 sc1
    buffer_load_dwordx4 v[114:117], v92, s[32:35], s77 offen offset:1024 sc1
    buffer_load_dwordx4 v[118:121], v92, s[32:35], s77 offen offset:2048 sc1
    buffer_load_dwordx4 v[122:125], v92, s[32:35], s77 offen offset:3072 sc1
L_ld2:
    s_cmp_lg_u32 s56, 1
    s_cbranch_scc1 L_rn0
    s_mov_b32 s57, 0
    s_mov_b32 s76, 5636096
L_ov:
    s_waitcnt vmcnt(0)
    v_cmp_ne_u32 vcc, s100, v77
    v_cmp_ne_u32 s[64:65], 0, v76
    s_add_u32 s57, s57, 1
    s_cmp_ge_u32 s57, 0x10000
    s_cbranch_scc1 L_ovd
    s_nop 0
    s_cbranch_vccz L_ovd
    buffer_load_dwordx2 v[76:77], v85, s[32:35], s76 offen sc1
    s_branch L_ov
L_ovd:
    s_mov_b32 s57, 0
L_rn0:
    v_and_b32 v87, 15, v1
    v_xor_b32 v88, v87, v3
    v_lshlrev_b32 v88, 4, v88
    v_lshl_add_u32 v88, v87, 9, v88
    s_waitcnt vmcnt(0)
    s_cmp_eq_u64 s[64:65], 0
    s_cbranch_scc0 L_round
    v_add_u32 v4, 50176, v88
    v_xor_b32 v5, 64, v4
    v_xor_b32 v6, 128, v4
    v_xor_b32 v7, 192, v4
    v_xor_b32 v8, 256, v4
    v_xor_b32 v9, 320, v4
    v_xor_b32 v10, 384, v4
    v_xor_b32 v11, 448, v4
    v_add_u32 v89, s4, v87
    v_lshlrev_b32 v89, 9, v89
    v_lshl_add_u32 v89, v3, 3, v89
    s_lshl_b32 s76, s3, 5
    s_add_u32 s77, s76, 8192
    s_add_u32 s78, s76, 16384
    s_sub_u32 s5, s5, 32
    v_cmp_gt_u32 s[70:71], s5, v87
    v_mov_b32 v12, s74
    v_lshrrev_b32 v13, 1, v3
    s_lshl_b32 s77, s3, 1
    v_or_b32 v13, s77, v13
    v_xor_b32 v13, v13, v87
    v_lshlrev_b32 v13, 4, v13
    v_lshl_add_u32 v13, v87, 9, v13
    v_and_b32 v14, 1, v3
    v_lshl_add_u32 v13, v14, 3, v13
    v_lshrrev_b32 v14, 5, v0
    v_cmp_gt_u32 vcc, s5, v14
    v_and_b32 v14, 15, v14
    v_lshlrev_b32 v14, 4, v14
    v_xor_b32 v14, v14, v2
    v_add_u32 v15, 0x4000, v2
    v_mov_b32 v16, 0x7ffffff0
    s_lshl_b32 s76, s4, 9
    v_cndmask_b32 v15, v16, v15, vcc
    s_waitcnt lgkmcnt(0)
    s_barrier
    ds_read_b128 v[40:43], v4 offset:0
    ds_read_b128 v[44:47], v5 offset:0
    ds_read_b128 v[48:51], v6 offset:0
    ds_read_b128 v[52:55], v7 offset:0
    s_waitcnt lgkmcnt(3)
    v_mfma_f32_16x16x32_bf16 v[64:67], v[94:97], v[40:43], v[64:67]
    ds_read_b128 v[40:43], v8 offset:0
    s_waitcnt lgkmcnt(3)
    v_mfma_f32_16x16x32_bf16 v[64:67], v[98:101], v[44:47], v[64:67]
    ds_read_b128 v[44:47], v9 offset:0
    s_waitcnt lgkmcnt(3)
    v_mfma_f32_16x16x32_bf16 v[64:67], v[102:105], v[48:51], v[64:67]
    ds_read_b128 v[48:51], v10 offset:0
    s_waitcnt lgkmcnt(3)
    v_mfma_f32_16x16x32_bf16 v[64:67], v[106:109], v[52:55], v[64:67]
    ds_read_b128 v[52:55], v11 offset:0
    s_waitcnt lgkmcnt(3)
    v_mfma_f32_16x16x32_bf16 v[64:67], v[110:113], v[40:43], v[64:67]
    ds_read_b128 v[40:43], v4 offset:8192
    s_waitcnt lgkmcnt(3)
    v_mfma_f32_16x16x32_bf16 v[64:67], v[114:117], v[44:47], v[64:67]
    ds_read_b128 v[44:47], v5 offset:8192
    s_waitcnt lgkmcnt(3)
    v_mfma_f32_16x16x32_bf16 v[64:67], v[118:121], v[48:51], v[64:67]
    ds_read_b128 v[48:51], v6 offset:8192
    s_waitcnt lgkmcnt(3)
    v_mfma_f32_16x16x32_bf16 v[64:67], v[122:125], v[52:55], v[64:67]
    ds_read_b128 v[52:55], v7 offset:8192
    s_waitcnt lgkmcnt(3)
    v_mfma_f32_16x16x32_bf16 v[68:71], v[94:97], v[40:43], v[68:71]
    ds_read_b128 v[40:43], v8 offset:8192
    s_waitcnt lgkmcnt(3)
    v_mfma_f32_16x16x32_bf16 v[68:71], v[98:101], v[44:47], v[68:71]
    ds_read_b128 v[44:47], v9 offset:8192
    s_waitcnt lgkmcnt(3)
    v_mfma_f32_16x16x32_bf16 v[68:71], v[102:105], v[48:51], v[68:71]
    v_exp_f32 v56, v64
    v_exp_f32 v57, v65
    v_exp_f32 v58, v66
    v_exp_f32 v59, v67
    ds_read_b128 v[48:51], v10 offset:8192
    s_waitcnt lgkmcnt(3)
    v_mfma_f32_16x16x32_bf16 v[68:71], v[106:109], v[52:55], v[68:71]
    v_fma_f32 v56, v56, v12, v12
    v_fma_f32 v57, v57, v12, v12
    v_fma_f32 v58, v58, v12, v12
    v_fma_f32 v59, v59, v12, v12
    ds_read_b128 v[52:55], v11 offset:8192
    s_waitcnt lgkmcnt(3)
    v_mfma_f32_16x16x32_bf16 v[68:71], v[110:113], v[40:43], v[68:71]
    v_rcp_f32 v56, v56
    v_rcp_f32 v57, v57
    v_rcp_f32 v58, v58
    v_rcp_f32 v59, v59
    ds_read_b128 v[40:43], v4 offset:16384
    s_waitcnt lgkmcnt(3)
    v_mfma_f32_16x16x32_bf16 v[68:71], v[114:117], v[44:47], v[68:71]
    v_mul_f32 v64, v64, v56
    v_mul_f32 v65, v65, v57
    v_mul_f32 v66, v66, v58
    v_mul_f32 v67, v67, v59
    ds_read_b128 v[44:47], v5 offset:16384
    s_waitcnt lgkmcnt(3)
    v_mfma_f32_16x16x32_bf16 v[68:71], v[118:121], v[48:51], v[68:71]
    v_cvt_pk_bf16_f32 v64, v64, v65
    v_cvt_pk_bf16_f32 v65, v66, v67
    ds_write_b64 v13, v[64:65] offset:0
    ds_read_b128 v[48:51], v6 offset:16384
    s_waitcnt lgkmcnt(3)
    v_mfma_f32_16x16x32_bf16 v[68:71], v[122:125], v[52:55], v[68:71]
    ds_read_b128 v[52:55], v7 offset:16384
    s_waitcnt lgkmcnt(3)
    v_mfma_f32_16x16x32_bf16 v[72:75], v[94:97], v[40:43], v[72:75]
    ds_read_b128 v[40:43], v8 offset:16384
    s_waitcnt lgkmcnt(3)
    v_mfma_f32_16x16x32_bf16 v[72:75], v[98:101], v[44:47], v[72:75]
    ds_read_b128 v[44:47], v9 offset:16384
    s_waitcnt lgkmcnt(3)
    v_mfma_f32_16x16x32_bf16 v[72:75], v[102:105], v[48:51], v[72:75]
    v_exp_f32 v56, v68
    v_exp_f32 v57, v69
    v_exp_f32 v58, v70
    v_exp_f32 v59, v71
    ds_read_b128 v[48:51], v10 offset:16384
    s_waitcnt lgkmcnt(3)
    v_mfma_f32_16x16x32_bf16 v[72:75], v[106:109], v[52:55], v[72:75]
    v_fma_f32 v56, v56, v12, v12
    v_fma_f32 v57, v57, v12, v12
    v_fma_f32 v58, v58, v12, v12
    v_fma_f32 v59, v59, v12, v12
    ds_read_b128 v[52:55], v11 offset:16384
    s_waitcnt lgkmcnt(3)
    v_mfma_f32_16x16x32_bf16 v[72:75], v[110:113], v[40:43], v[72:75]
    v_rcp_f32 v56, v56
    v_rcp_f32 v57, v57
    v_rcp_f32 v58, v58
    v_rcp_f32 v59, v59
    s_waitcnt lgkmcnt(2)
    v_mfma_f32_16x16x32_bf16 v[72:75], v[114:117], v[44:47], v[72:75]
    v_mul_f32 v68, v68, v56
    v_mul_f32 v69, v69, v57
    v_mul_f32 v70, v70, v58
    v_mul_f32 v71, v71, v59
    s_waitcnt lgkmcnt(1)
    v_mfma_f32_16x16x32_bf16 v[72:75], v[118:121], v[48:51], v[72:75]
    v_cvt_pk_bf16_f32 v68, v68, v69
    v_cvt_pk_bf16_f32 v69, v70, v71
    ds_write_b64 v13, v[68:69] offset:8192
    s_waitcnt lgkmcnt(0)
    v_mfma_f32_16x16x32_bf16 v[72:75], v[122:125], v[52:55], v[72:75]
    s_nop 7
    v_exp_f32 v56, v72
    v_exp_f32 v57, v73
    v_exp_f32 v58, v74
    v_exp_f32 v59, v75
    v_fma_f32 v56, v56, v12, v12
    v_fma_f32 v57, v57, v12, v12
    v_fma_f32 v58, v58, v12, v12
    v_fma_f32 v59, v59, v12, v12
    v_rcp_f32 v56, v56
    v_rcp_f32 v57, v57
    v_rcp_f32 v58, v58
    v_rcp_f32 v59, v59
    v_mul_f32 v72, v72, v56
    v_mul_f32 v73, v73, v57
    v_mul_f32 v74, v74, v58
    v_mul_f32 v75, v75, v59
    v_cvt_pk_bf16_f32 v72, v72, v73
    v_cvt_pk_bf16_f32 v73, v74, v75
    ds_write_b64 v13, v[72:73] offset:16384
    s_waitcnt lgkmcnt(0)
    s_barrier
    ds_read_b128 v[16:19], v14
    ds_read_b128 v[20:23], v14 offset:16384
    s_waitcnt lgkmcnt(1)
    buffer_store_dwordx4 v[16:19], v2, s[40:43], s76 offen sc1
    s_cmp_ge_u32 s3, 5
    s_cbranch_scc1 L_os
    s_waitcnt lgkmcnt(0)
    buffer_store_dwordx4 v[20:23], v15, s[40:43], s76 offen sc1
L_os:
L_end:
    s_endpgm
L_round:
    s_waitcnt lgkmcnt(0)
    s_barrier
    s_ff1_i32_b64 s76, s[64:65]
    s_mul_i32 s77, s76, 20000
    v_readlane_b32 s58, v76, s76
    s_lshl_b32 s78, s57, 3
    s_add_u32 s77, s77, s78
    s_add_u32 s77, s77, 5701632
    buffer_load_dwordx4 v[40:43], v2, s[32:35], s77 offen sc1
    v_lshlrev_b32 v87, 1, v0
    v_add_u32 v87, s57, v87
    v_add_u32 v88, 1, v87
    v_cmp_gt_u32 s[60:61], s58, v87
    v_cmp_gt_u32 s[62:63], s58, v88
    s_add_u32 s57, s57, 2048
    s_cmp_lt_u32 s57, s58
    s_cbranch_scc1 L_rn2
    s_bitset0_b64 s[64:65], s76
    s_mov_b32 s57, 0
L_rn2:
    s_waitcnt vmcnt(0)
    v_lshrrev_b32 v87, 16, v41
    v_lshrrev_b32 v88, 16, v43
    v_cmp_eq_u32 s[70:71], s2, v87
    s_nop 3
    s_and_b64 s[60:61], s[60:61], s[70:71]
    v_cmp_eq_u32 s[70:71], s2, v88
    s_nop 3
    s_and_b64 s[62:63], s[62:63], s[70:71]
    s_lshl_b32 s76, s4, 2
    s_sub_u32 s76, 132352, s76
    v_and_b32 v87, 0x3fff, v40
    v_and_b32 v88, 0x3fff, v42
    v_mov_b32 v90, 1
    v_lshl_add_u32 v87, v87, 2, s76
    v_lshl_add_u32 v88, v88, 2, s76
    s_mov_b64 exec, s[60:61]
    ds_add_rtn_u32 v4, v87, v90
    s_mov_b64 exec, s[62:63]
    ds_add_rtn_u32 v5, v88, v90
    s_mov_b64 exec, -1
    v_add_u32 v91, 132352, v81
    v_lshrrev_b32 v40, 5, v40
    v_lshrrev_b32 v42, 5, v42
    s_waitcnt lgkmcnt(0)
    s_barrier
    ds_read_b32 v89, v91
    v_and_b32 v40, 0x7ffe00, v40
    v_and_b32 v42, 0x7ffe00, v42
    s_mov_b32 s76, 91136
    s_mov_b32 s77, 99392
    s_waitcnt lgkmcnt(0)
    v_add_u32_dpp v86, v89, v89 row_shr:1 row_mask:0xf bank_mask:0xf bound_ctrl:0
    s_nop 1
    v_add_u32_dpp v86, v86, v86 row_shr:2 row_mask:0xf bank_mask:0xf bound_ctrl:0
    s_nop 1
    v_add_u32_dpp v86, v86, v86 row_shr:4 row_mask:0xf bank_mask:0xf bound_ctrl:0
    s_nop 1
    v_add_u32_dpp v86, v86, v86 row_shr:8 row_mask:0xf bank_mask:0xf bound_ctrl:0
    s_nop 1
    v_add_u32_dpp v86, v86, v86 row_bcast:15 row_mask:0xa bank_mask:0xf
    s_nop 1
    v_add_u32_dpp v86, v86, v86 row_bcast:31 row_mask:0xc bank_mask:0xf
    v_sub_u32 v90, v86, v89
    v_readlane_b32 s55, v86, 63
    ds_bpermute_b32 v87, v87, v90
    ds_bpermute_b32 v88, v88, v90
    s_nop 1
    s_add_u32 s27, s55, 15
    s_lshr_b32 s27, s27, 4
    s_mul_i32 s48, s27, s3
    s_add_u32 s49, s48, s27
    s_min_u32 s48, s48, s55
    s_min_u32 s49, s49, s55
    s_waitcnt lgkmcnt(0)
    v_add_u32 v87, v87, v4
    v_add_u32 v88, v88, v5
    v_lshl_add_u32 v89, v87, 2, s76
    v_lshl_add_u32 v90, v88, 2, s76
    v_lshl_add_u32 v87, v87, 4, s77
    v_lshl_add_u32 v88, v88, 4, s77
    s_mov_b64 exec, s[60:61]
    ds_write_b32 v89, v40
    ds_write_b16 v87, v41 offset:8
    ds_write_b16 v87, v41 offset:14
    s_mov_b64 exec, s[62:63]
    ds_write_b32 v90, v42
    ds_write_b16 v88, v43 offset:8
    ds_write_b16 v88, v43 offset:14
    s_mov_b64 exec, -1
    s_waitcnt lgkmcnt(0)
    s_barrier
    s_branch L_pr
L_ugemm:
    ds_read_b128 v[48:51], v80 offset:0
    ds_read_b128 v[52:55], v80 offset:8192
    ds_read_b128 v[56:59], v80 offset:16384
    v_xor_b32 v93, 64, v80
    ds_read_b128 v[60:63], v93 offset:0
    s_waitcnt vmcnt(20)
    s_waitcnt lgkmcnt(3)
    v_mfma_f32_16x16x32_bf16 v[64:67], v[94:97], v[48:51], 0
    ds_read_b128 v[48:51], v93 offset:8192
    s_waitcnt lgkmcnt(3)
    v_mfma_f32_16x16x32_bf16 v[68:71], v[94:97], v[52:55], 0
    ds_read_b128 v[52:55], v93 offset:16384
    s_waitcnt lgkmcnt(3)
    v_mfma_f32_16x16x32_bf16 v[72:75], v[94:97], v[56:59], 0
    v_xor_b32 v93, 128, v80
    ds_read_b128 v[56:59], v93 offset:0
    s_waitcnt vmcnt(19)
    s_waitcnt lgkmcnt(3)
    v_mfma_f32_16x16x32_bf16 v[64:67], v[98:101], v[60:63], v[64:67]
    ds_read_b128 v[60:63], v93 offset:8192
    s_waitcnt lgkmcnt(3)
    v_mfma_f32_16x16x32_bf16 v[68:71], v[98:101], v[48:51], v[68:71]
    ds_read_b128 v[48:51], v93 offset:16384
    s_waitcnt lgkmcnt(3)
    v_mfma_f32_16x16x32_bf16 v[72:75], v[98:101], v[52:55], v[72:75]
    v_xor_b32 v93, 192, v80
    ds_read_b128 v[52:55], v93 offset:0
    s_waitcnt vmcnt(18)
    s_waitcnt lgkmcnt(3)
    v_mfma_f32_16x16x32_bf16 v[64:67], v[102:105], v[56:59], v[64:67]
    ds_read_b128 v[56:59], v93 offset:8192
    s_waitcnt lgkmcnt(3)
    v_mfma_f32_16x16x32_bf16 v[68:71], v[102:105], v[60:63], v[68:71]
    ds_read_b128 v[60:63], v93 offset:16384
    s_waitcnt lgkmcnt(3)
    v_mfma_f32_16x16x32_bf16 v[72:75], v[102:105], v[48:51], v[72:75]
    v_xor_b32 v93, 256, v80
    ds_read_b128 v[48:51], v93 offset:0
    s_waitcnt vmcnt(17)
    s_waitcnt lgkmcnt(3)
    v_mfma_f32_16x16x32_bf16 v[64:67], v[106:109], v[52:55], v[64:67]
    ds_read_b128 v[52:55], v93 offset:8192
    s_waitcnt lgkmcnt(3)
    v_mfma_f32_16x16x32_bf16 v[68:71], v[106:109], v[56:59], v[68:71]
    ds_read_b128 v[56:59], v93 offset:16384
    s_waitcnt lgkmcnt(3)
    v_mfma_f32_16x16x32_bf16 v[72:75], v[106:109], v[60:63], v[72:75]
    v_xor_b32 v93, 320, v80
    ds_read_b128 v[60:63], v93 offset:0
    s_waitcnt vmcnt(16)
    s_waitcnt lgkmcnt(3)
    v_mfma_f32_16x16x32_bf16 v[64:67], v[110:113], v[48:51], v[64:67]
    ds_read_b128 v[48:51], v93 offset:8192
    s_waitcnt lgkmcnt(3)
    v_mfma_f32_16x16x32_bf16 v[68:71], v[110:113], v[52:55], v[68:71]
    ds_read_b128 v[52:55], v93 offset:16384
    s_waitcnt lgkmcnt(3)
    v_mfma_f32_16x16x32_bf16 v[72:75], v[110:113], v[56:59], v[72:75]
    v_xor_b32 v93, 384, v80
    ds_read_b128 v[56:59], v93 offset:0
    s_waitcnt vmcnt(15)
    s_waitcnt lgkmcnt(3)
    v_mfma_f32_16x16x32_bf16 v[64:67], v[114:117], v[60:63], v[64:67]
    ds_read_b128 v[60:63], v93 offset:8192
    s_waitcnt lgkmcnt(3)
    v_mfma_f32_16x16x32_bf16 v[68:71], v[114:117], v[48:51], v[68:71]
    ds_read_b128 v[48:51], v93 offset:16384
    s_waitcnt lgkmcnt(3)
    v_mfma_f32_16x16x32_bf16 v[72:75], v[114:117], v[52:55], v[72:75]
    v_xor_b32 v93, 448, v80
    ds_read_b128 v[52:55], v93 offset:0
    s_waitcnt vmcnt(14)
    s_waitcnt lgkmcnt(3)
    v_mfma_f32_16x16x32_bf16 v[64:67], v[118:121], v[56:59], v[64:67]
    ds_read_b128 v[56:59], v93 offset:8192
    s_waitcnt lgkmcnt(3)
    v_mfma_f32_16x16x32_bf16 v[68:71], v[118:121], v[60:63], v[68:71]
    ds_read_b128 v[60:63], v93 offset:16384
    s_waitcnt lgkmcnt(3)
    v_mfma_f32_16x16x32_bf16 v[72:75], v[118:121], v[48:51], v[72:75]
    s_waitcnt vmcnt(13)
    s_waitcnt lgkmcnt(2)
    v_mfma_f32_16x16x32_bf16 v[64:67], v[122:125], v[52:55], v[64:67]
    s_waitcnt lgkmcnt(1)
    v_mfma_f32_16x16x32_bf16 v[68:71], v[122:125], v[56:59], v[68:71]
    s_waitcnt lgkmcnt(0)
    v_mfma_f32_16x16x32_bf16 v[72:75], v[122:125], v[60:63], v[72:75]
    s_nop 5
    v_pk_mul_f32 v[64:65], v[64:65], s[74:75]
    v_pk_mul_f32 v[66:67], v[66:67], s[74:75]
    v_pk_mul_f32 v[68:69], v[68:69], s[74:75]
    v_pk_mul_f32 v[70:71], v[70:71], s[74:75]
    v_pk_mul_f32 v[72:73], v[72:73], s[74:75]
    v_pk_mul_f32 v[74:75], v[74:75], s[74:75]
    s_setpc_b64 s[66:67]
F_ovf:
    s_mul_i32 s50, s2, 20000
    s_add_u32 s50, s50, 5701632
    v_mov_b32 v87, 132096
    v_cmp_gt_u32 vcc, 28, v24
    s_and_saveexec_b64 s[62:63], vcc
    ds_write2_b32 v8, v28, v16 offset0:0 offset1:1
    s_andn2_b64 exec, s[62:63], exec
    s_cbranch_execz F_no0
    ds_add_rtn_u32 v91, v87, v90
    v_mov_b32 v88, v28
    v_and_b32 v89, 0xffff, v16
    v_lshl_or_b32 v89, v20, 16, v89
    s_waitcnt lgkmcnt(0)
    v_lshlrev_b32 v91, 3, v91
    buffer_store_dwordx2 v[88:89], v91, s[32:35], s50 offen sc1
    s_waitcnt vmcnt(0)
F_no0:
    s_mov_b64 exec, s[62:63]
    v_cmp_gt_u32 vcc, 28, v25
    s_and_saveexec_b64 s[62:63], vcc
    ds_write2_b32 v9, v29, v18 offset0:0 offset1:1
    s_andn2_b64 exec, s[62:63], exec
    s_cbranch_execz F_no1
    ds_add_rtn_u32 v91, v87, v90
    v_mov_b32 v88, v29
    v_and_b32 v89, 0xffff, v18
    v_lshl_or_b32 v89, v21, 16, v89
    s_waitcnt lgkmcnt(0)
    v_lshlrev_b32 v91, 3, v91
    buffer_store_dwordx2 v[88:89], v91, s[32:35], s50 offen sc1
    s_waitcnt vmcnt(0)
F_no1:
    s_mov_b64 exec, s[62:63]
    v_cmp_gt_u32 vcc, 28, v26
    s_and_saveexec_b64 s[62:63], vcc
    ds_write2_b32 v10, v30, v17 offset0:0 offset1:1
    s_andn2_b64 exec, s[62:63], exec
    s_cbranch_execz F_no2
    ds_add_rtn_u32 v91, v87, v90
    v_mov_b32 v88, v30
    v_and_b32 v89, 0xffff, v17
    v_lshl_or_b32 v89, v22, 16, v89
    s_waitcnt lgkmcnt(0)
    v_lshlrev_b32 v91, 3, v91
    buffer_store_dwordx2 v[88:89], v91, s[32:35], s50 offen sc1
    s_waitcnt vmcnt(0)
F_no2:
    s_mov_b64 exec, s[62:63]
    v_cmp_gt_u32 vcc, 28, v27
    s_and_saveexec_b64 s[62:63], vcc
    ds_write2_b32 v11, v31, v19 offset0:0 offset1:1
    s_andn2_b64 exec, s[62:63], exec
    s_cbranch_execz F_no3
    ds_add_rtn_u32 v91, v87, v90
    v_mov_b32 v88, v31
    v_and_b32 v89, 0xffff, v19
    v_lshl_or_b32 v89, v23, 16, v89
    s_waitcnt lgkmcnt(0)
    v_lshlrev_b32 v91, 3, v91
    buffer_store_dwordx2 v[88:89], v91, s[32:35], s50 offen sc1
    s_waitcnt vmcnt(0)
F_no3:
    s_mov_b64 exec, s[62:63]
    s_branch F_ovfback
.section .rodata,"a"
.p2align 6
.amdhsa_kernel gather_scatter__mpnn_edge_mlp__graph_kernel
  .amdhsa_next_free_vgpr 127
  .amdhsa_next_free_sgpr 102
  .amdhsa_accum_offset 128
  .amdhsa_group_segment_fixed_size 0
  .amdhsa_kernarg_size 72
  .amdhsa_user_sgpr_count 2
  .amdhsa_user_sgpr_kernarg_segment_ptr 1
  .amdhsa_system_sgpr_workgroup_id_x 1
.end_amdhsa_kernel
```
